```python
import torch

def _softmax(x, axis=-1):
    return torch.softmax(x, dim=axis)
def _gelu(x):
    return torch.nn.functional.gelu(x, approximate="tanh")
def _silu(x):
    return torch.nn.functional.silu(x)
def _sigmoid(x):
    return torch.sigmoid(x)
def _layernorm(x, axis=-1, eps=1e-5):
    m = x.mean(dim=axis, keepdim=True)
    v = x.var(dim=axis, keepdim=True, unbiased=False)
    return (x - m) / torch.sqrt(v + eps)
def _scatter_add(tgt, idx, src, axis=0):
    return tgt.clone().index_add_(axis, idx, src)
def _segment_sum(src, seg, n):
    out = torch.zeros((n,) + src.shape[1:], dtype=src.dtype)
    return out.index_add_(0, seg, src)
def _pad(x, pw):
    flat = tuple(v for pair in reversed(pw) for v in pair)
    return torch.nn.functional.pad(x, flat)

kernel_name = 'sequential_preLN__sliding_block_cached__dense_activation_relu__decode'

def setup_inputs():

    _w = (lambda a: (lambda t: t.to(torch.bfloat16) if t.is_floating_point() else t)(torch.as_tensor(a)))
    def _A_setup():
        B, Sq, D = 1, 1, 576
        Hq, Hkv, Sk, Dh = 32, 16, 65536, 128
        assert Hq % Hkv == 0, (Hq, Hkv)
        return {
            "x": _w((lambda *s: torch.randn(*s, dtype=torch.bfloat16) * 0.05)(B, Sq, D)),
            "k_cache": _w((lambda *s: torch.randn(*s, dtype=torch.bfloat16) * 3.2)(B, Hkv, Sk, Dh)),
            "v_cache": _w((lambda *s: torch.randn(*s, dtype=torch.bfloat16) * 0.4)(B, Hkv, Sk, Dh)),
            "wq": _w((lambda *s: torch.randn(*s, dtype=torch.bfloat16) * 3.2)(D, Hq * Dh) * (D ** -0.5)),
            "wo": _w((lambda *s: torch.randn(*s, dtype=torch.bfloat16) * 0.4)(Hq * Dh, D) * ((Hq * Dh) ** -0.5)),
        }
    _A_in = _A_setup()

    def _B_setup():
        B, S, D, Dff = 1, 1, 576, 4608
        return {
            "x": _w((lambda *s: torch.randn(*s, dtype=torch.bfloat16) * 0.05)(B, S, D)),
            "w1": _w((lambda *s: torch.randn(*s, dtype=torch.bfloat16) * 0.05)(D, Dff)),
            "w2": _w((lambda *s: torch.randn(*s, dtype=torch.bfloat16) * 0.05)(Dff, D)),
        }
    _B_in = _B_setup()

    return {
        "A_x": _A_in["x"],
        "A_k_cache": _A_in["k_cache"],
        "A_v_cache": _A_in["v_cache"],
        "A_wq": _A_in["wq"],
        "A_wo": _A_in["wo"],
        "B_x": _B_in["x"],
        "B_w1": _B_in["w1"],
        "B_w2": _B_in["w2"],
    }

def reference(A_x, A_k_cache, A_v_cache, A_wq, A_wo, B_x, B_w1, B_w2):
    def _A_ref(x, k_cache, v_cache, wq, wo):
        B, Sq, D = x.shape
        Hq, Dh = 32, 128
        Hkv, Sk = k_cache.shape[1], k_cache.shape[2]
        W = min(4096, max(256, Sk // 4))
        rep = Hq // Hkv
        q = (lambda x, *d: x.permute(*d))((x @ wq).reshape(B, Sq, Hq, Dh), 0, 2, 1, 3)
        k = (lambda x, n, axis: torch.repeat_interleave(x, n, dim=axis))(k_cache[:, :, Sk - W:, :], rep, axis=1)
        v = (lambda x, n, axis: torch.repeat_interleave(x, n, dim=axis))(v_cache[:, :, Sk - W:, :], rep, axis=1)
        scores = torch.einsum("bhqd,bhkd->bhqk", q, k) * (Dh ** -0.5)
        p = _softmax(scores, axis=-1)
        o = torch.einsum("bhqk,bhkd->bhqd", p, v)
        return (lambda x, *d: x.permute(*d))(o, 0, 2, 1, 3).reshape(B, Sq, Hq * Dh) @ wo

    def _B_ref(x, w1, w2):
        h = torch.einsum("bsd,df->bsf", x, w1)
        zero = torch.zeros_like(h)
        h = torch.maximum(h, zero)
        return torch.einsum("bsf,fd->bsd", h, w2)

    x = A_x
    h = x + _A_ref(_layernorm(x, axis=-1), A_k_cache, A_v_cache, A_wq, A_wo)
    h2 = h + _B_ref(_layernorm(h, axis=-1), B_w1, B_w2)
    return h2
```

```asm
; @launch grid=(256,1,1) block=(576,1,1) lds=94208
.amdgcn_target "amdgcn-amd-amdhsa--gfx950"
.text
.globl sequential_preLN__sliding_block_cached__dense_activation_relu__decode_kernel
.p2align 8
.type sequential_preLN__sliding_block_cached__dense_activation_relu__decode_kernel,@function
sequential_preLN__sliding_block_cached__dense_activation_relu__decode_kernel:
s_cmp_ge_u32 s2, 256
s_cbranch_scc1 L_exit
s_load_dwordx16 s[4:19], s[0:1], 0
s_load_dwordx2 s[20:21], s[0:1], 64
s_load_dwordx4 s[24:27], s[0:1], 72
v_lshrrev_b32 v1, 6, v0
v_and_b32 v0, 63, v0
v_readfirstlane_b32 s3, v1
s_and_b32 s22, s2, 15
s_lshr_b32 s23, s2, 4
s_mov_b32 s38, 0xffffff00
s_mov_b32 s39, 0xffff0000
v_lshrrev_b32 v1, 4, v0
v_and_b32 v2, 15, v0
v_and_b32 v3, 7, v0
s_cmp_eq_u32 s3, 0
s_cbranch_scc0 L_comp0
s_mov_b32 s96, 0
s_setprio 3
v_lshlrev_b32 v8, 3, v0
v_lshlrev_b32 v9, 1, v0
v_lshrrev_b32 v14, 3, v0
v_lshlrev_b32 v15, 13, v14
v_lshl_add_u32 v15, v3, 4, v15
s_lshr_b32 s46, s23, 2
s_mul_i32 s47, s46, 1179648
s_lshl_b32 s48, s22, 9
s_add_u32 s47, s47, s48
s_and_b32 s48, s23, 3
s_lshl_b32 s48, s48, 7
s_add_u32 s47, s47, s48
s_waitcnt lgkmcnt(0)
global_load_dwordx2 v[20:21], v8, s[4:5]
global_load_dwordx2 v[22:23], v8, s[4:5] offset:512
global_load_ushort v28, v9, s[4:5] offset:1024
s_load_dword s28, s[26:27], 0
s_add_u32 s10, s10, s47
s_addc_u32 s11, s11, 0
global_load_dwordx4 v[64:67], v15, s[10:11] nt
s_add_u32 s10, s10, 65536
s_addc_u32 s11, s11, 0
global_load_dwordx4 v[68:71], v15, s[10:11] nt
s_add_u32 s10, s10, 65536
s_addc_u32 s11, s11, 0
global_load_dwordx4 v[72:75], v15, s[10:11] nt
s_add_u32 s10, s10, 65536
s_addc_u32 s11, s11, 0
global_load_dwordx4 v[76:79], v15, s[10:11] nt
s_add_u32 s10, s10, 65536
s_addc_u32 s11, s11, 0
global_load_dwordx4 v[80:83], v15, s[10:11] nt
s_add_u32 s10, s10, 65536
s_addc_u32 s11, s11, 0
global_load_dwordx4 v[84:87], v15, s[10:11] nt
s_add_u32 s10, s10, 65536
s_addc_u32 s11, s11, 0
global_load_dwordx4 v[88:91], v15, s[10:11] nt
s_add_u32 s10, s10, 65536
s_addc_u32 s11, s11, 0
global_load_dwordx4 v[92:95], v15, s[10:11] nt
s_add_u32 s10, s10, 65536
s_addc_u32 s11, s11, 0
global_load_dwordx4 v[96:99], v15, s[10:11] nt
s_add_u32 s10, s10, 65536
s_addc_u32 s11, s11, 0
global_load_dwordx4 v[100:103], v15, s[10:11] nt
s_add_u32 s10, s10, 65536
s_addc_u32 s11, s11, 0
global_load_dwordx4 v[104:107], v15, s[10:11] nt
s_add_u32 s10, s10, 65536
s_addc_u32 s11, s11, 0
global_load_dwordx4 v[108:111], v15, s[10:11] nt
s_add_u32 s10, s10, 65536
s_addc_u32 s11, s11, 0
global_load_dwordx4 v[112:115], v15, s[10:11] nt
s_add_u32 s10, s10, 65536
s_addc_u32 s11, s11, 0
global_load_dwordx4 v[116:119], v15, s[10:11] nt
s_add_u32 s10, s10, 65536
s_addc_u32 s11, s11, 0
global_load_dwordx4 v[120:123], v15, s[10:11] nt
s_add_u32 s10, s10, 65536
s_addc_u32 s11, s11, 0
global_load_dwordx4 v[124:127], v15, s[10:11] nt
s_add_u32 s10, s10, 65536
s_addc_u32 s11, s11, 0
global_load_dwordx4 v[128:131], v15, s[10:11] nt
s_add_u32 s10, s10, 65536
s_addc_u32 s11, s11, 0
global_load_dwordx4 v[132:135], v15, s[10:11] nt
s_barrier
s_branch L_common
L_comp0:
s_mov_b32 s96, 1
s_cmp_lt_u32 s23, 4
s_cselect_b32 s46, 5, 9
s_cselect_b32 s48, 0, 4294836224
s_lshl_b32 s47, s23, 3
s_add_u32 s47, s47, s3
s_sub_u32 s47, s47, 1
s_mul_i32 s46, s46, s47
s_lshl_b32 s46, s46, 10
s_add_u32 s46, s46, s48
s_lshl_b32 s47, s22, 24
s_add_u32 s46, s46, s47
s_add_u32 s46, s46, 15732736
v_lshlrev_b32 v8, 4, v0
v_add_u32 v17, 1024, v8
v_bfe_u32 v9, v0, 2, 2
v_lshlrev_b32 v9, 8, v9
v_lshl_add_u32 v9, v1, 6, v9
v_and_b32 v14, 3, v0
v_lshl_add_u32 v9, v14, 4, v9
v_add_u32 v15, 1024, v9
v_lshrrev_b32 v14, 3, v0
v_mul_u32_u24 v10, 1152, v14
v_lshlrev_b32 v18, 1, v1
v_xor_b32 v18, v18, v3
v_lshl_add_u32 v10, v18, 4, v10
v_lshrrev_b32 v14, 2, v0
v_mul_u32_u24 v11, 9216, v14
v_and_b32 v14, 3, v0
v_lshl_add_u32 v11, v14, 4, v11
s_waitcnt lgkmcnt(0)
s_load_dword s28, s[26:27], 0
s_add_u32 s6, s6, s46
s_addc_u32 s7, s7, 0
s_add_u32 s8, s8, s46
s_addc_u32 s9, s9, 0
s_lshl_b32 s46, s22, 2
s_add_u32 s46, s46, s23
s_mul_i32 s46, s46, 73728
s_lshl_b32 s47, s3, 7
s_add_u32 s46, s46, s47
s_add_u32 s12, s12, s46
s_addc_u32 s13, s13, 0
s_and_b32 s29, s2, 7
s_mul_i32 s29, s29, 18
s_lshr_b32 s46, s22, 3
s_mul_i32 s46, s46, 9
s_add_u32 s29, s29, s46
s_add_u32 s29, s29, s23
s_sub_u32 s29, s29, 4
s_mul_i32 s46, s29, 36864
s_add_u32 s46, s46, s47
s_add_u32 s18, s18, s46
s_addc_u32 s19, s19, 0
s_mul_i32 s46, s3, 589824
s_lshl_b32 s47, s29, 6
s_add_u32 s46, s46, s47
s_add_u32 s16, s16, s46
s_addc_u32 s17, s17, 0
s_lshl_b32 s47, s3, 13
s_add_u32 s47, s47, 20480
s_cmp_eq_u32 s3, 8
s_cbranch_scc0 L_nopf
s_getpc_b64 s[50:51]
L_pc:
v_lshlrev_b32 v14, 7, v0
v_add_u32 v18, 8192, v14
v_min_u32 v18, L_exit-L_pc, v18
v_min_u32 v14, L_exit-L_pc, v14
global_load_dword v30, v14, s[50:51]
global_load_dword v31, v18, s[50:51]
L_nopf:
s_barrier
s_cmp_lt_u32 s2, 64
s_cbranch_scc0 L_first_kv
s_add_u32 s49, s47, 0
s_mov_b32 m0, s49
s_nop 0
global_load_lds_dwordx4 v10, s[12:13] nt
s_add_u32 s12, s12, 9216
s_addc_u32 s13, s13, 0
s_add_u32 s49, s47, 1024
s_mov_b32 m0, s49
s_nop 0
global_load_lds_dwordx4 v10, s[12:13] nt
s_add_u32 s12, s12, 9216
s_addc_u32 s13, s13, 0
s_add_u32 s49, s47, 2048
s_mov_b32 m0, s49
s_nop 0
global_load_lds_dwordx4 v10, s[12:13] nt
s_add_u32 s12, s12, 9216
s_addc_u32 s13, s13, 0
s_branch L_common
L_first_kv:
global_load_dwordx4 v[52:55], v9, s[6:7] offset:-4096 nt
global_load_dwordx4 v[56:59], v9, s[6:7] offset:-3072 nt
global_load_dwordx4 v[60:63], v9, s[6:7] offset:-2048 nt
L_common:
v_mov_b32 v4, 0
v_mov_b32 v5, 0
v_mov_b32 v6, 0
v_mov_b32 v7, 0
v_and_b32 v14, 1, v0
v_mov_b32 v18, 0xffff
v_lshlrev_b32 v14, 4, v14
v_lshlrev_b32 v18, v14, v18
s_mov_b32 exec_lo, 0x3030303
s_mov_b32 exec_hi, 0x3030303
v_mov_b32 v4, v18
s_mov_b32 exec_lo, 0xc0c0c0c
s_mov_b32 exec_hi, 0xc0c0c0c
v_mov_b32 v5, v18
s_mov_b32 exec_lo, 0x30303030
s_mov_b32 exec_hi, 0x30303030
v_mov_b32 v6, v18
s_mov_b32 exec_lo, 0xc0c0c0c0
s_mov_b32 exec_hi, 0xc0c0c0c0
v_mov_b32 v7, v18
s_mov_b64 exec, -1
s_mov_b32 s32, 0x22222222
s_mov_b32 s33, s32
s_mov_b32 s34, 0x44444444
s_mov_b32 s35, s34
s_mov_b32 s36, 0x88888888
s_mov_b32 s37, s36
s_cmp_eq_u32 s96, 0
s_cbranch_scc0 L_comp1
v_lshrrev_b32 v14, 3, v0
v_mul_u32_u24 v10, 1152, v14
v_lshlrev_b32 v18, 1, v1
v_xor_b32 v18, v18, v3
v_lshl_add_u32 v10, v18, 4, v10
v_lshrrev_b32 v14, 2, v0
v_mul_u32_u24 v11, 9216, v14
v_and_b32 v14, 3, v0
v_lshl_add_u32 v11, v14, 4, v11
s_lshl_b32 s46, s22, 2
s_add_u32 s46, s46, s23
s_mul_i32 s46, s46, 73728
s_lshl_b32 s47, s3, 7
s_add_u32 s46, s46, s47
s_add_u32 s12, s12, s46
s_addc_u32 s13, s13, 0
s_and_b32 s29, s2, 7
s_mul_i32 s29, s29, 18
s_lshr_b32 s46, s22, 3
s_mul_i32 s46, s46, 9
s_add_u32 s29, s29, s46
s_add_u32 s29, s29, s23
s_sub_u32 s29, s29, 4
s_mul_i32 s46, s29, 36864
s_add_u32 s46, s46, s47
s_add_u32 s18, s18, s46
s_addc_u32 s19, s19, 0
s_mul_i32 s46, s3, 589824
s_lshl_b32 s47, s29, 6
s_add_u32 s46, s46, s47
s_add_u32 s16, s16, s46
s_addc_u32 s17, s17, 0
s_lshl_b32 s47, s3, 13
s_add_u32 s47, s47, 20480
s_lshl_b32 s46, s22, 13
s_add_u32 s46, s46, 4096
s_add_u32 s40, s26, s46
s_addc_u32 s41, s27, 0
s_lshl_b32 s46, s23, 9
v_lshlrev_b32 v160, 6, v3
v_lshl_add_u32 v160, v1, 5, v160
v_add_u32 v160, s46, v160
s_lshl_b32 s46, s22, 14
s_lshl_b32 s49, s23, 8
s_add_u32 s46, s46, s49
s_add_u32 s46, s46, 262144
s_add_u32 s56, s26, s46
s_addc_u32 s57, s27, 0
v_lshrrev_b32 v14, 5, v0
v_lshrrev_b32 v161, 3, v2
v_lshl_add_u32 v161, v14, 1, v161
v_lshlrev_b32 v161, 12, v161
v_lshl_add_u32 v161, v3, 5, v161
v_and_b32 v19, 1, v1
v_lshl_add_u32 v161, v19, 4, v161
s_lshl_b32 s46, s22, 8
s_lshl_b32 s49, s23, 3
s_add_u32 s46, s46, s49
s_add_u32 s46, s46, 589824
s_add_u32 s58, s26, s46
s_addc_u32 s59, s27, 0
v_lshlrev_b32 v162, 7, v14
s_add_u32 s60, s40, 3145728
s_addc_u32 s61, s41, 0
s_add_u32 s62, s56, 3145728
s_addc_u32 s63, s57, 0
s_add_u32 s14, s58, 3145728
s_addc_u32 s15, s59, 0
s_waitcnt lgkmcnt(0)
v_mov_b32 v52, s28
v_mov_b32 v53, s28
v_mov_b32 v54, s28
v_mov_b32 v55, s28
s_mov_b64 exec, 0x00ff00ff
global_store_dwordx4 v160, v[52:55], s[60:61]
global_store_dwordx4 v160, v[52:55], s[60:61] offset:16
s_mov_b64 exec, -1
global_store_dwordx4 v161, v[52:55], s[62:63]
s_mov_b32 exec_lo, 1
s_mov_b32 exec_hi, 1
global_store_dwordx2 v162, v[52:53], s[14:15]
s_mov_b64 exec, -1
s_waitcnt vmcnt(22)
v_lshlrev_b32 v30, 16, v20
v_and_b32 v31, s39, v20
v_lshlrev_b32 v32, 16, v21
v_and_b32 v33, s39, v21
v_lshlrev_b32 v34, 16, v22
v_and_b32 v35, s39, v22
v_lshlrev_b32 v36, 16, v23
v_and_b32 v37, s39, v23
v_lshlrev_b32 v38, 16, v28
v_add_f32 v40, v30, v31
v_add_f32 v40, v40, v32
v_add_f32 v40, v40, v33
v_add_f32 v40, v40, v34
v_add_f32 v40, v40, v35
v_add_f32 v40, v40, v36
v_add_f32 v40, v40, v37
v_add_f32 v40, v40, v38
s_nop 1
v_add_f32_dpp v40, v40, v40 row_ror:8 row_mask:0xf bank_mask:0xf
s_nop 1
v_add_f32_dpp v40, v40, v40 row_ror:4 row_mask:0xf bank_mask:0xf
s_nop 1
v_add_f32_dpp v40, v40, v40 row_ror:2 row_mask:0xf bank_mask:0xf
s_nop 1
v_add_f32_dpp v40, v40, v40 row_ror:1 row_mask:0xf bank_mask:0xf
s_nop 1
v_add_f32_dpp v40, v40, v40 row_bcast:15 row_mask:0xa bank_mask:0xf
s_nop 1
v_add_f32_dpp v40, v40, v40 row_bcast:31 row_mask:0xc bank_mask:0xf
s_nop 0
v_readlane_b32 s46, v40, 63
v_mov_b32 v41, 0x3ae38e39
s_nop 0
v_mul_f32 v41, s46, v41
v_sub_f32 v42, v30, v41
v_sub_f32 v43, v31, v41
v_sub_f32 v44, v32, v41
v_sub_f32 v45, v33, v41
v_sub_f32 v46, v34, v41
v_sub_f32 v47, v35, v41
v_sub_f32 v48, v36, v41
v_sub_f32 v49, v37, v41
v_sub_f32 v50, v38, v41
v_mul_f32 v40, v42, v42
v_fmac_f32 v40, v43, v43
v_fmac_f32 v40, v44, v44
v_fmac_f32 v40, v45, v45
v_fmac_f32 v40, v46, v46
v_fmac_f32 v40, v47, v47
v_fmac_f32 v40, v48, v48
v_fmac_f32 v40, v49, v49
v_fmac_f32 v40, v50, v50
v_cvt_pk_bf16_f32 v41, v41, v41
v_and_b32 v41, s39, v41
v_add_f32_dpp v40, v40, v40 row_ror:8 row_mask:0xf bank_mask:0xf
s_nop 1
v_add_f32_dpp v40, v40, v40 row_ror:4 row_mask:0xf bank_mask:0xf
s_nop 1
v_add_f32_dpp v40, v40, v40 row_ror:2 row_mask:0xf bank_mask:0xf
s_nop 1
v_add_f32_dpp v40, v40, v40 row_ror:1 row_mask:0xf bank_mask:0xf
s_nop 1
v_add_f32_dpp v40, v40, v40 row_bcast:15 row_mask:0xa bank_mask:0xf
s_nop 1
v_add_f32_dpp v40, v40, v40 row_bcast:31 row_mask:0xc bank_mask:0xf
s_nop 0
v_readlane_b32 s46, v40, 63
v_sub_f32 v30, v30, v41
v_sub_f32 v31, v31, v41
v_sub_f32 v32, v32, v41
v_sub_f32 v33, v33, v41
v_sub_f32 v34, v34, v41
v_sub_f32 v35, v35, v41
v_sub_f32 v36, v36, v41
v_sub_f32 v37, v37, v41
v_sub_f32 v38, v38, v41
v_mov_b32 v40, 0x3ae38e39
v_mul_f32 v40, s46, v40
v_cvt_pk_bf16_f32 v40, v40, v40
v_and_b32 v40, s39, v40
v_add_f32 v40, 0x3727c5ac, v40
v_cvt_pk_bf16_f32 v40, v40, v40
v_and_b32 v40, s39, v40
v_sqrt_f32 v40, v40
v_cvt_pk_bf16_f32 v42, v30, v31
v_lshlrev_b32 v30, 16, v42
v_and_b32 v31, s39, v42
v_cvt_pk_bf16_f32 v42, v32, v33
v_lshlrev_b32 v32, 16, v42
v_and_b32 v33, s39, v42
v_cvt_pk_bf16_f32 v42, v34, v35
v_lshlrev_b32 v34, 16, v42
v_and_b32 v35, s39, v42
v_cvt_pk_bf16_f32 v42, v36, v37
v_lshlrev_b32 v36, 16, v42
v_and_b32 v37, s39, v42
v_cvt_pk_bf16_f32 v38, v38, v38
v_and_b32 v38, s39, v38
v_cvt_pk_bf16_f32 v40, v40, v40
v_and_b32 v40, s39, v40
v_rcp_f32 v41, v40
s_nop 0
v_mul_f32 v42, v30, v41
v_mul_f32 v43, v31, v41
v_mul_f32 v44, v32, v41
v_mul_f32 v45, v33, v41
v_mul_f32 v46, v34, v41
v_mul_f32 v47, v35, v41
v_mul_f32 v48, v36, v41
v_mul_f32 v49, v37, v41
v_mul_f32 v50, v38, v41
v_fma_f32 v30, -v42, v40, v30
v_fma_f32 v31, -v43, v40, v31
v_fma_f32 v32, -v44, v40, v32
v_fma_f32 v33, -v45, v40, v33
v_fma_f32 v34, -v46, v40, v34
v_fma_f32 v35, -v47, v40, v35
v_fma_f32 v36, -v48, v40, v36
v_fma_f32 v37, -v49, v40, v37
v_fma_f32 v38, -v50, v40, v38
v_fma_f32 v30, v30, v41, v42
v_fma_f32 v31, v31, v41, v43
v_fma_f32 v32, v32, v41, v44
v_fma_f32 v33, v33, v41, v45
v_fma_f32 v34, v34, v41, v46
v_fma_f32 v35, v35, v41, v47
v_fma_f32 v36, v36, v41, v48
v_fma_f32 v37, v37, v41, v49
v_fma_f32 v38, v38, v41, v50
v_cvt_pk_bf16_f32 v40, v30, v30
v_cvt_pk_bf16_f32 v41, v31, v31
v_cvt_pk_bf16_f32 v42, v32, v32
v_cvt_pk_bf16_f32 v43, v33, v33
v_cvt_pk_bf16_f32 v44, v34, v34
v_cvt_pk_bf16_f32 v45, v35, v35
v_cvt_pk_bf16_f32 v46, v36, v36
v_cvt_pk_bf16_f32 v47, v37, v37
v_cvt_pk_bf16_f32 v48, v38, v38
v_lshlrev_b32 v14, 4, v0
v_lshlrev_b32 v18, 2, v0
ds_write_b128 v14, v[40:43] offset:0
ds_write_b128 v14, v[44:47] offset:1024
ds_write_b32 v18, v48 offset:2048
s_lshr_b32 s46, s23, 2
s_mul_i32 s46, s46, 576
v_lshrrev_b32 v14, 3, v0
v_lshl_add_u32 v14, v14, 2, s46
ds_read_b32 v140, v14 offset:0
ds_read_b32 v141, v14 offset:32
ds_read_b32 v142, v14 offset:64
ds_read_b32 v143, v14 offset:96
ds_read_b32 v144, v14 offset:128
ds_read_b32 v145, v14 offset:160
ds_read_b32 v146, v14 offset:192
ds_read_b32 v147, v14 offset:224
ds_read_b32 v148, v14 offset:256
ds_read_b32 v149, v14 offset:288
ds_read_b32 v150, v14 offset:320
ds_read_b32 v151, v14 offset:352
ds_read_b32 v152, v14 offset:384
ds_read_b32 v153, v14 offset:416
ds_read_b32 v154, v14 offset:448
ds_read_b32 v155, v14 offset:480
ds_read_b32 v156, v14 offset:512
ds_read_b32 v157, v14 offset:544
s_waitcnt lgkmcnt(0)
s_add_u32 s28, s28, 1
v_and_b32 v20, v4, v140
v_and_b32 v21, v5, v140
v_and_b32 v22, v6, v140
v_and_b32 v23, v7, v140
s_waitcnt vmcnt(21)
s_nop 0
v_mfma_f32_16x16x32_bf16 v[32:35], v[20:23], v[64:67], 0
v_and_b32 v24, v4, v141
v_and_b32 v25, v5, v141
v_and_b32 v26, v6, v141
v_and_b32 v27, v7, v141
s_waitcnt vmcnt(20)
s_nop 0
v_mfma_f32_16x16x32_bf16 v[32:35], v[24:27], v[68:71], v[32:35]
v_and_b32 v20, v4, v142
v_and_b32 v21, v5, v142
v_and_b32 v22, v6, v142
v_and_b32 v23, v7, v142
s_waitcnt vmcnt(19)
s_nop 0
v_mfma_f32_16x16x32_bf16 v[32:35], v[20:23], v[72:75], v[32:35]
v_and_b32 v24, v4, v143
v_and_b32 v25, v5, v143
v_and_b32 v26, v6, v143
v_and_b32 v27, v7, v143
s_waitcnt vmcnt(18)
s_nop 0
v_mfma_f32_16x16x32_bf16 v[32:35], v[24:27], v[76:79], v[32:35]
v_and_b32 v20, v4, v144
v_and_b32 v21, v5, v144
v_and_b32 v22, v6, v144
v_and_b32 v23, v7, v144
s_waitcnt vmcnt(17)
s_nop 0
v_mfma_f32_16x16x32_bf16 v[32:35], v[20:23], v[80:83], v[32:35]
v_and_b32 v24, v4, v145
v_and_b32 v25, v5, v145
v_and_b32 v26, v6, v145
v_and_b32 v27, v7, v145
s_waitcnt vmcnt(16)
s_nop 0
v_mfma_f32_16x16x32_bf16 v[32:35], v[24:27], v[84:87], v[32:35]
v_and_b32 v20, v4, v146
v_and_b32 v21, v5, v146
v_and_b32 v22, v6, v146
v_and_b32 v23, v7, v146
s_waitcnt vmcnt(15)
s_nop 0
v_mfma_f32_16x16x32_bf16 v[32:35], v[20:23], v[88:91], v[32:35]
v_and_b32 v24, v4, v147
v_and_b32 v25, v5, v147
v_and_b32 v26, v6, v147
v_and_b32 v27, v7, v147
s_waitcnt vmcnt(14)
s_nop 0
v_mfma_f32_16x16x32_bf16 v[32:35], v[24:27], v[92:95], v[32:35]
v_and_b32 v20, v4, v148
v_and_b32 v21, v5, v148
v_and_b32 v22, v6, v148
v_and_b32 v23, v7, v148
s_waitcnt vmcnt(13)
s_nop 0
v_mfma_f32_16x16x32_bf16 v[32:35], v[20:23], v[96:99], v[32:35]
v_and_b32 v24, v4, v149
v_and_b32 v25, v5, v149
v_and_b32 v26, v6, v149
v_and_b32 v27, v7, v149
s_waitcnt vmcnt(12)
s_nop 0
v_mfma_f32_16x16x32_bf16 v[32:35], v[24:27], v[100:103], v[32:35]
v_and_b32 v20, v4, v150
v_and_b32 v21, v5, v150
v_and_b32 v22, v6, v150
v_and_b32 v23, v7, v150
s_waitcnt vmcnt(11)
s_nop 0
v_mfma_f32_16x16x32_bf16 v[32:35], v[20:23], v[104:107], v[32:35]
v_and_b32 v24, v4, v151
v_and_b32 v25, v5, v151
v_and_b32 v26, v6, v151
v_and_b32 v27, v7, v151
s_waitcnt vmcnt(10)
s_nop 0
v_mfma_f32_16x16x32_bf16 v[32:35], v[24:27], v[108:111], v[32:35]
v_and_b32 v20, v4, v152
v_and_b32 v21, v5, v152
v_and_b32 v22, v6, v152
v_and_b32 v23, v7, v152
s_waitcnt vmcnt(9)
s_nop 0
v_mfma_f32_16x16x32_bf16 v[32:35], v[20:23], v[112:115], v[32:35]
v_and_b32 v24, v4, v153
v_and_b32 v25, v5, v153
v_and_b32 v26, v6, v153
v_and_b32 v27, v7, v153
s_waitcnt vmcnt(8)
s_nop 0
v_mfma_f32_16x16x32_bf16 v[32:35], v[24:27], v[116:119], v[32:35]
v_and_b32 v20, v4, v154
v_and_b32 v21, v5, v154
v_and_b32 v22, v6, v154
v_and_b32 v23, v7, v154
s_waitcnt vmcnt(7)
s_nop 0
v_mfma_f32_16x16x32_bf16 v[32:35], v[20:23], v[120:123], v[32:35]
v_and_b32 v24, v4, v155
v_and_b32 v25, v5, v155
v_and_b32 v26, v6, v155
v_and_b32 v27, v7, v155
s_waitcnt vmcnt(6)
s_nop 0
v_mfma_f32_16x16x32_bf16 v[32:35], v[24:27], v[124:127], v[32:35]
v_and_b32 v20, v4, v156
v_and_b32 v21, v5, v156
v_and_b32 v22, v6, v156
v_and_b32 v23, v7, v156
s_waitcnt vmcnt(5)
s_nop 0
v_mfma_f32_16x16x32_bf16 v[32:35], v[20:23], v[128:131], v[32:35]
v_and_b32 v24, v4, v157
v_and_b32 v25, v5, v157
v_and_b32 v26, v6, v157
v_and_b32 v27, v7, v157
s_waitcnt vmcnt(4)
s_nop 0
v_mfma_f32_16x16x32_bf16 v[32:35], v[24:27], v[132:135], v[32:35]
v_add_u32 v14, 40, v0
v_and_b32 v14, 63, v14
v_lshlrev_b32 v14, 2, v14
s_nop 4
ds_bpermute_b32 v36, v14, v32
ds_bpermute_b32 v37, v14, v33
ds_bpermute_b32 v38, v14, v34
ds_bpermute_b32 v39, v14, v35
v_mov_b32 v41, s28
v_mov_b32 v43, s28
v_mov_b32 v45, s28
v_mov_b32 v47, s28
s_waitcnt lgkmcnt(0)
v_add_f32 v40, v32, v36
v_add_f32 v42, v33, v37
v_add_f32 v44, v34, v38
v_add_f32 v46, v35, v39
s_mov_b64 exec, 0x00ff00ff
global_store_dwordx4 v160, v[40:43], s[60:61]
global_store_dwordx4 v160, v[44:47], s[60:61] offset:16
s_mov_b64 exec, -1
v_lshlrev_b32 v8, 4, v0
s_add_u32 s42, s40, 4096
s_addc_u32 s43, s41, 0
s_mov_b32 s30, 0
s_mov_b64 s[52:53], s[42:43]
L_poll_A:
s_and_b32 s31, s30, 31
s_cmp_eq_u32 s31, 31
s_cselect_b32 s31, 0, 3145728
s_add_u32 s42, s52, s31
s_addc_u32 s43, s53, 0
s_cmp_eq_u32 s30, 24
s_cbranch_scc0 L_nsp_A
s_mov_b64 exec, 0x00ff00ff
global_store_dwordx4 v160, v[40:43], s[40:41] sc1
global_store_dwordx4 v160, v[44:47], s[40:41] offset:16 sc1
s_mov_b64 exec, -1
L_nsp_A:
global_load_dwordx4 v[64:67], v8, s[42:43] offset:-4096 sc1
global_load_dwordx4 v[68:71], v8, s[42:43] offset:-3072 sc1
global_load_dwordx4 v[72:75], v8, s[42:43] offset:-2048 sc1
global_load_dwordx4 v[76:79], v8, s[42:43] offset:-1024 sc1
global_load_dwordx4 v[80:83], v8, s[42:43] offset:0 sc1
global_load_dwordx4 v[84:87], v8, s[42:43] offset:1024 sc1
global_load_dwordx4 v[88:91], v8, s[42:43] offset:2048 sc1
global_load_dwordx4 v[92:95], v8, s[42:43] offset:3072 sc1
s_add_u32 s30, s30, 1
s_cmp_gt_u32 s30, 30000
s_cbranch_scc1 L_end
s_waitcnt vmcnt(0)
v_bitop3_b32 v20, v65, v67, s28 bitop3:0x7e
v_bitop3_b32 v20, v69, s28, v20 bitop3:0xbe
v_bitop3_b32 v20, v71, s28, v20 bitop3:0xbe
v_bitop3_b32 v20, v73, s28, v20 bitop3:0xbe
v_bitop3_b32 v20, v75, s28, v20 bitop3:0xbe
v_bitop3_b32 v20, v77, s28, v20 bitop3:0xbe
v_bitop3_b32 v20, v79, s28, v20 bitop3:0xbe
v_bitop3_b32 v20, v81, s28, v20 bitop3:0xbe
v_bitop3_b32 v20, v83, s28, v20 bitop3:0xbe
v_bitop3_b32 v20, v85, s28, v20 bitop3:0xbe
v_bitop3_b32 v20, v87, s28, v20 bitop3:0xbe
v_bitop3_b32 v20, v89, s28, v20 bitop3:0xbe
v_bitop3_b32 v20, v91, s28, v20 bitop3:0xbe
v_bitop3_b32 v20, v93, s28, v20 bitop3:0xbe
v_bitop3_b32 v20, v95, s28, v20 bitop3:0xbe
v_cmp_ne_u32 vcc, 0, v20
s_cbranch_vccnz L_poll_A
v_add_f32 v64, v64, v72
v_add_f32 v64, v64, v80
v_add_f32 v64, v64, v88
v_add_f32 v66, v66, v74
v_add_f32 v66, v66, v82
v_add_f32 v66, v66, v90
v_cvt_pk_bf16_f32 v20, v64, v66
v_add_f32 v68, v68, v76
v_add_f32 v68, v68, v84
v_add_f32 v68, v68, v92
v_add_f32 v70, v70, v78
v_add_f32 v70, v70, v86
v_add_f32 v70, v70, v94
v_cvt_pk_bf16_f32 v21, v68, v70
v_lshlrev_b32 v18, 2, v0
ds_write_b32 v18, v20 offset:2560
ds_write_b32 v18, v21 offset:2816
s_waitcnt lgkmcnt(0)
s_barrier
s_cmp_le_u32 s30, 24
s_cbranch_scc0 L_nsq_A
s_mov_b64 exec, 0x00ff00ff
global_store_dwordx4 v160, v[40:43], s[40:41] sc1
global_store_dwordx4 v160, v[44:47], s[40:41] offset:16 sc1
s_mov_b64 exec, -1
L_nsq_A:
s_lshl_b32 s46, s22, 2
s_add_u32 s46, s46, s23
s_lshl_b32 s46, s46, 12
s_add_u32 s46, s46, 262144
s_add_u32 s42, s26, s46
s_addc_u32 s43, s27, 0
s_lshl_b32 s46, s22, 8
s_lshr_b32 s49, s23, 1
s_lshl_b32 s49, s49, 7
s_add_u32 s46, s46, s49
s_add_u32 s46, s46, 589824
s_add_u32 s44, s26, s46
s_addc_u32 s45, s27, 0
v_and_b32 v19, 3, v0
v_lshl_add_u32 v163, v19, 2, v1
v_lshlrev_b32 v163, 3, v163
v_lshlrev_b32 v164, 4, v19
v_bfe_u32 v19, v0, 2, 1
v_lshl_add_u32 v164, v19, 3, v164
v_lshl_add_u32 v164, v1, 1, v164
v_bfe_u32 v19, v0, 3, 1
v_lshl_add_u32 v164, v19, 6, v164
s_cmp_lt_u32 s2, 64
s_cbranch_scc0 L_c_nwo
s_add_u32 s49, s47, 0
s_mov_b32 m0, s49
s_nop 0
global_load_lds_dwordx4 v10, s[12:13] nt
s_add_u32 s12, s12, 9216
s_addc_u32 s13, s13, 0
s_add_u32 s49, s47, 1024
s_mov_b32 m0, s49
s_nop 0
global_load_lds_dwordx4 v10, s[12:13] nt
s_add_u32 s12, s12, 9216
s_addc_u32 s13, s13, 0
s_add_u32 s49, s47, 2048
s_mov_b32 m0, s49
s_nop 0
global_load_lds_dwordx4 v10, s[12:13] nt
s_add_u32 s12, s12, 9216
s_addc_u32 s13, s13, 0
s_add_u32 s49, s47, 3072
s_mov_b32 m0, s49
s_nop 0
global_load_lds_dwordx4 v10, s[12:13] nt
s_add_u32 s12, s12, 9216
s_addc_u32 s13, s13, 0
s_add_u32 s49, s47, 4096
s_mov_b32 m0, s49
s_nop 0
global_load_lds_dwordx4 v10, s[12:13] nt
s_add_u32 s12, s12, 9216
s_addc_u32 s13, s13, 0
s_add_u32 s49, s47, 5120
s_mov_b32 m0, s49
s_nop 0
global_load_lds_dwordx4 v10, s[12:13] nt
s_add_u32 s12, s12, 9216
s_addc_u32 s13, s13, 0
s_add_u32 s49, s47, 6144
s_mov_b32 m0, s49
s_nop 0
global_load_lds_dwordx4 v10, s[12:13] nt
s_add_u32 s12, s12, 9216
s_addc_u32 s13, s13, 0
s_add_u32 s49, s47, 7168
s_mov_b32 m0, s49
s_nop 0
global_load_lds_dwordx4 v10, s[12:13] nt
s_add_u32 s12, s12, 9216
s_addc_u32 s13, s13, 0
s_add_u32 s52, s42, 3145728
s_addc_u32 s53, s43, 0
s_add_u32 s54, s44, 3145728
s_addc_u32 s55, s45, 0
global_load_dwordx2 v[132:133], v163, s[54:55] sc1
global_load_dwordx4 v[116:119], v8, s[52:53] offset:0 sc1
global_load_dwordx4 v[120:123], v8, s[52:53] offset:1024 sc1
global_load_dwordx4 v[124:127], v8, s[52:53] offset:2048 sc1
global_load_dwordx4 v[128:131], v8, s[52:53] offset:3072 sc1
s_branch L_c_w
L_c_nwo:
s_cmp_lt_u32 s2, 208
s_cbranch_scc0 L_c_w
s_add_u32 s49, s47, 0
s_mov_b32 m0, s49
s_nop 0
global_load_lds_dwordx4 v11, s[16:17] nt
s_add_u32 s16, s16, 147456
s_addc_u32 s17, s17, 0
s_add_u32 s49, s47, 1024
s_mov_b32 m0, s49
s_nop 0
global_load_lds_dwordx4 v11, s[16:17] nt
s_add_u32 s16, s16, 147456
s_addc_u32 s17, s17, 0
s_add_u32 s49, s47, 2048
s_mov_b32 m0, s49
s_nop 0
global_load_lds_dwordx4 v11, s[16:17] nt
s_add_u32 s16, s16, 147456
s_addc_u32 s17, s17, 0
s_add_u32 s49, s47, 3072
s_mov_b32 m0, s49
s_nop 0
global_load_lds_dwordx4 v11, s[16:17] nt
s_add_u32 s16, s16, 147456
s_addc_u32 s17, s17, 0
s_add_u32 s49, s47, 4096
s_mov_b32 m0, s49
s_nop 0
global_load_lds_dwordx4 v10, s[18:19] nt
s_add_u32 s18, s18, 9216
s_addc_u32 s19, s19, 0
s_add_u32 s49, s47, 5120
s_mov_b32 m0, s49
s_nop 0
global_load_lds_dwordx4 v10, s[18:19] nt
s_add_u32 s18, s18, 9216
s_addc_u32 s19, s19, 0
s_add_u32 s49, s47, 6144
s_mov_b32 m0, s49
s_nop 0
global_load_lds_dwordx4 v10, s[18:19] nt
s_add_u32 s18, s18, 9216
s_addc_u32 s19, s19, 0
s_add_u32 s49, s47, 7168
s_mov_b32 m0, s49
s_nop 0
global_load_lds_dwordx4 v10, s[18:19] nt
s_add_u32 s18, s18, 9216
s_addc_u32 s19, s19, 0
L_c_w:
v_lshrrev_b32 v14, 5, v0
v_lshlrev_b32 v14, 5, v14
v_mov_b32 v29, s28
s_barrier
ds_read_b128 v[20:23], v14 offset:3072
ds_read_b128 v[24:27], v14 offset:3088
s_waitcnt lgkmcnt(0)
v_max3_f32 v20, v20, v21, v22
v_max3_f32 v23, v23, v24, v25
v_max3_f32 v20, v20, v26, v27
v_max_f32 v20, v20, v23
v_bfi_b32 v56, s38, v20, v29
s_barrier
ds_read_b128 v[64:67], v8 offset:12288
ds_read_b128 v[68:71], v8 offset:13312
ds_read_b128 v[72:75], v8 offset:14336
ds_read_b128 v[76:79], v8 offset:15360
ds_read_b128 v[80:83], v8 offset:16384
ds_read_b128 v[84:87], v8 offset:17408
ds_read_b128 v[88:91], v8 offset:18432
ds_read_b128 v[92:95], v8 offset:19456
ds_read_b128 v[20:23], v14 offset:3136
ds_read_b128 v[24:27], v14 offset:3152
s_waitcnt lgkmcnt(2)
v_pk_add_f32 v[64:65], v[64:65], v[68:69]
v_pk_add_f32 v[66:67], v[66:67], v[70:71]
v_pk_add_f32 v[72:73], v[72:73], v[76:77]
v_pk_add_f32 v[74:75], v[74:75], v[78:79]
v_pk_add_f32 v[80:81], v[80:81], v[84:85]
v_pk_add_f32 v[82:83], v[82:83], v[86:87]
v_pk_add_f32 v[88:89], v[88:89], v[92:93]
v_pk_add_f32 v[90:91], v[90:91], v[94:95]
v_pk_add_f32 v[64:65], v[64:65], v[72:73]
v_pk_add_f32 v[66:67], v[66:67], v[74:75]
v_pk_add_f32 v[80:81], v[80:81], v[88:89]
v_pk_add_f32 v[82:83], v[82:83], v[90:91]
v_pk_add_f32 v[64:65], v[64:65], v[80:81]
v_pk_add_f32 v[66:67], v[66:67], v[82:83]
v_bfi_b32 v60, s38, v64, v29
v_bfi_b32 v61, s38, v65, v29
v_bfi_b32 v62, s38, v66, v29
v_bfi_b32 v63, s38, v67, v29
global_store_dwordx4 v161, v[60:63], s[62:63]
s_waitcnt lgkmcnt(0)
v_pk_add_f32 v[20:21], v[20:21], v[22:23]
v_pk_add_f32 v[24:25], v[24:25], v[26:27]
v_pk_add_f32 v[20:21], v[20:21], v[24:25]
v_add_f32 v20, v20, v21
v_bfi_b32 v57, s38, v20, v29
s_mov_b32 exec_lo, 1
s_mov_b32 exec_hi, 1
global_store_dwordx2 v162, v[56:57], s[14:15]
s_mov_b64 exec, -1
s_cmp_lt_u32 s2, 64
s_cbranch_scc1 L_wo
global_store_dwordx4 v161, v[60:63], s[56:57] sc1
s_mov_b32 exec_lo, 1
s_mov_b32 exec_hi, 1
global_store_dwordx2 v162, v[56:57], s[58:59] sc1
s_mov_b64 exec, -1
s_barrier
s_cmp_lt_u32 s2, 208
s_cbranch_scc1 L_mlp
s_branch L_red
L_comp1:
s_cmp_lt_u32 s2, 64
s_cbranch_scc0 L_a_notwo
s_waitcnt vmcnt(2)
s_add_u32 s49, s47, 3072
s_mov_b32 m0, s49
s_nop 0
global_load_lds_dwordx4 v10, s[12:13] nt
s_add_u32 s12, s12, 9216
s_addc_u32 s13, s13, 0
s_waitcnt vmcnt(2)
s_add_u32 s49, s47, 4096
s_mov_b32 m0, s49
s_nop 0
global_load_lds_dwordx4 v10, s[12:13] nt
s_add_u32 s12, s12, 9216
s_addc_u32 s13, s13, 0
s_waitcnt vmcnt(2)
s_add_u32 s49, s47, 5120
s_mov_b32 m0, s49
s_nop 0
global_load_lds_dwordx4 v10, s[12:13] nt
s_add_u32 s12, s12, 9216
s_addc_u32 s13, s13, 0
s_waitcnt vmcnt(2)
s_add_u32 s49, s47, 6144
s_mov_b32 m0, s49
s_nop 0
global_load_lds_dwordx4 v10, s[12:13] nt
s_add_u32 s12, s12, 9216
s_addc_u32 s13, s13, 0
s_waitcnt vmcnt(2)
s_add_u32 s49, s47, 7168
s_mov_b32 m0, s49
s_nop 0
global_load_lds_dwordx4 v10, s[12:13] nt
s_add_u32 s12, s12, 9216
s_addc_u32 s13, s13, 0
s_waitcnt vmcnt(2)
global_load_dwordx4 v[52:55], v9, s[6:7] offset:-4096 nt
s_waitcnt vmcnt(2)
global_load_dwordx4 v[56:59], v9, s[6:7] offset:-3072 nt
s_waitcnt vmcnt(2)
global_load_dwordx4 v[60:63], v9, s[6:7] offset:-2048 nt
s_waitcnt vmcnt(2)
global_load_dwordx4 v[64:67], v9, s[6:7] offset:-1024 nt
s_waitcnt vmcnt(2)
global_load_dwordx4 v[68:71], v9, s[6:7] offset:0 nt
s_waitcnt vmcnt(2)
global_load_dwordx4 v[88:91], v8, s[8:9] offset:-4096 nt
s_waitcnt vmcnt(2)
global_load_dwordx4 v[92:95], v8, s[8:9] offset:-3072 nt
s_waitcnt vmcnt(2)
global_load_dwordx4 v[96:99], v8, s[8:9] offset:-2048 nt
s_waitcnt vmcnt(2)
global_load_dwordx4 v[100:103], v8, s[8:9] offset:-1024 nt
s_waitcnt vmcnt(2)
global_load_dwordx4 v[104:107], v8, s[8:9] offset:0 nt
v_lshrrev_b32 v14, 3, v2
v_lshlrev_b32 v18, 8, v14
v_lshl_add_u32 v18, v1, 6, v18
v_and_b32 v19, 3, v0
v_lshl_add_u32 v18, v19, 4, v18
v_lshlrev_b32 v14, 5, v14
s_lshl_b32 s46, s3, 2
s_sub_u32 s46, s46, 4
v_add_u32 v19, s46, v14
s_waitcnt lgkmcnt(0)
s_add_u32 s28, s28, 1
v_mov_b32 v29, s28
s_barrier
ds_read_b128 v[20:23], v18 offset:2560
s_waitcnt lgkmcnt(0)
v_mfma_f32_16x16x32_bf16 v[124:127], v[52:55], v[20:23], 0
v_mfma_f32_16x16x32_bf16 v[128:131], v[56:59], v[20:23], 0
v_mfma_f32_16x16x32_bf16 v[132:135], v[60:63], v[20:23], 0
v_mfma_f32_16x16x32_bf16 v[136:139], v[64:67], v[20:23], 0
v_mfma_f32_16x16x32_bf16 v[140:143], v[68:71], v[20:23], 0
s_nop 3
v_cndmask_b32 v32, v124, v125, s[32:33]
v_cndmask_b32 v33, v128, v129, s[32:33]
v_cndmask_b32 v34, v132, v133, s[32:33]
v_cndmask_b32 v35, v136, v137, s[32:33]
v_cndmask_b32 v36, v140, v141, s[32:33]
v_cndmask_b32 v32, v32, v126, s[34:35]
v_cndmask_b32 v33, v33, v130, s[34:35]
v_cndmask_b32 v34, v34, v134, s[34:35]
v_cndmask_b32 v35, v35, v138, s[34:35]
v_cndmask_b32 v36, v36, v142, s[34:35]
v_cndmask_b32 v32, v32, v127, s[36:37]
v_cndmask_b32 v33, v33, v131, s[36:37]
v_cndmask_b32 v34, v34, v135, s[36:37]
v_cndmask_b32 v35, v35, v139, s[36:37]
v_cndmask_b32 v36, v36, v143, s[36:37]
v_add_f32_dpp v32, v32, v32 quad_perm:[1,0,3,2] row_mask:0xf bank_mask:0xf
v_add_f32_dpp v33, v33, v33 quad_perm:[1,0,3,2] row_mask:0xf bank_mask:0xf
v_add_f32_dpp v34, v34, v34 quad_perm:[1,0,3,2] row_mask:0xf bank_mask:0xf
v_add_f32_dpp v35, v35, v35 quad_perm:[1,0,3,2] row_mask:0xf bank_mask:0xf
v_add_f32_dpp v36, v36, v36 quad_perm:[1,0,3,2] row_mask:0xf bank_mask:0xf
v_add_f32_dpp v32, v32, v32 quad_perm:[2,3,0,1] row_mask:0xf bank_mask:0xf
v_add_f32_dpp v33, v33, v33 quad_perm:[2,3,0,1] row_mask:0xf bank_mask:0xf
v_add_f32_dpp v34, v34, v34 quad_perm:[2,3,0,1] row_mask:0xf bank_mask:0xf
v_add_f32_dpp v35, v35, v35 quad_perm:[2,3,0,1] row_mask:0xf bank_mask:0xf
v_add_f32_dpp v36, v36, v36 quad_perm:[2,3,0,1] row_mask:0xf bank_mask:0xf
v_cvt_pk_bf16_f32 v42, v32, v33
v_cvt_pk_bf16_f32 v43, v34, v35
v_cvt_pk_bf16_f32 v44, v36, v36
v_lshlrev_b32 v32, 16, v42
v_and_b32 v33, s39, v42
v_lshlrev_b32 v34, 16, v43
v_and_b32 v35, s39, v43
v_lshlrev_b32 v36, 16, v44
v_mul_f32 v32, 0x3db504f3, v32
v_mul_f32 v33, 0x3db504f3, v33
v_mul_f32 v34, 0x3db504f3, v34
v_mul_f32 v35, 0x3db504f3, v35
v_mul_f32 v36, 0x3db504f3, v36
v_cvt_pk_bf16_f32 v42, v32, v33
v_cvt_pk_bf16_f32 v43, v34, v35
v_cvt_pk_bf16_f32 v44, v36, v36
v_lshlrev_b32 v32, 16, v42
v_and_b32 v33, s39, v42
v_lshlrev_b32 v34, 16, v43
v_and_b32 v35, s39, v43
v_lshlrev_b32 v36, 16, v44
v_max3_f32 v42, v32, v33, v34
v_max3_f32 v42, v42, v35, v36
v_mov_b32 v43, v42
s_nop 1
v_permlane16_swap_b32 v43, v42
v_max_f32 v42, v42, v43
v_mov_b32 v43, v42
s_nop 1
v_permlane32_swap_b32 v43, v42
v_max_f32 v42, v42, v43
s_mov_b64 exec, 0x101
ds_write_b32 v19, v42 offset:3072
s_mov_b64 exec, -1
s_waitcnt lgkmcnt(0)
s_barrier
ds_read_b128 v[20:23], v14 offset:3072
ds_read_b128 v[24:27], v14 offset:3088
s_waitcnt lgkmcnt(0)
v_max3_f32 v20, v20, v21, v22
v_max3_f32 v23, v23, v24, v25
v_max3_f32 v20, v20, v26, v27
v_max_f32 v20, v20, v23
v_sub_f32 v32, v32, v20
v_sub_f32 v33, v33, v20
v_sub_f32 v34, v34, v20
v_sub_f32 v35, v35, v20
v_sub_f32 v36, v36, v20
v_mul_f32 v32, 0x3fb8aa3b, v32
v_mul_f32 v33, 0x3fb8aa3b, v33
v_mul_f32 v34, 0x3fb8aa3b, v34
v_mul_f32 v35, 0x3fb8aa3b, v35
v_mul_f32 v36, 0x3fb8aa3b, v36
v_exp_f32 v32, v32
v_exp_f32 v33, v33
v_exp_f32 v34, v34
v_exp_f32 v35, v35
v_exp_f32 v36, v36
v_add_f32 v42, v32, v33
v_add_f32 v42, v42, v34
v_add_f32 v42, v42, v35
v_add_f32 v42, v42, v36
v_cvt_pk_bf16_f32 v32, v32, v32
v_cvt_pk_bf16_f32 v33, v33, v33
v_cvt_pk_bf16_f32 v34, v34, v34
v_cvt_pk_bf16_f32 v35, v35, v35
v_cvt_pk_bf16_f32 v36, v36, v36
v_mov_b32 v43, v42
s_nop 1
v_permlane16_swap_b32 v43, v42
v_add_f32 v42, v42, v43
v_mov_b32 v43, v42
s_nop 1
v_permlane32_swap_b32 v43, v42
v_add_f32 v42, v42, v43
v_and_b32 v124, v4, v32
v_and_b32 v125, v5, v32
v_and_b32 v126, v6, v32
v_and_b32 v127, v7, v32
v_and_b32 v128, v4, v33
v_and_b32 v129, v5, v33
v_and_b32 v130, v6, v33
v_and_b32 v131, v7, v33
v_and_b32 v132, v4, v34
v_and_b32 v133, v5, v34
v_and_b32 v134, v6, v34
v_and_b32 v135, v7, v34
v_and_b32 v136, v4, v35
v_and_b32 v137, v5, v35
v_and_b32 v138, v6, v35
v_and_b32 v139, v7, v35
v_and_b32 v140, v4, v36
v_and_b32 v141, v5, v36
v_and_b32 v142, v6, v36
v_and_b32 v143, v7, v36
s_mov_b64 exec, 0x101
ds_write_b32 v19, v42 offset:3136
s_mov_b64 exec, -1
s_lshl_b32 s46, s3, 10
v_add_u32 v18, s46, v8
s_waitcnt vmcnt(4)
v_mfma_f32_16x16x32_bf16 v[20:23], v[124:127], v[88:91], 0
s_waitcnt vmcnt(3)
v_mfma_f32_16x16x32_bf16 v[20:23], v[128:131], v[92:95], v[20:23]
s_waitcnt vmcnt(2)
v_mfma_f32_16x16x32_bf16 v[20:23], v[132:135], v[96:99], v[20:23]
s_waitcnt vmcnt(1)
v_mfma_f32_16x16x32_bf16 v[20:23], v[136:139], v[100:103], v[20:23]
s_waitcnt vmcnt(0)
v_mfma_f32_16x16x32_bf16 v[20:23], v[140:143], v[104:107], v[20:23]
s_nop 7
ds_write_b128 v18, v[20:23] offset:11264
s_waitcnt lgkmcnt(0)
s_barrier
s_branch L_wo
L_a_notwo:
s_waitcnt vmcnt(2)
global_load_dwordx4 v[64:67], v9, s[6:7] offset:-1024 nt
s_waitcnt vmcnt(2)
global_load_dwordx4 v[68:71], v9, s[6:7] offset:0 nt
s_waitcnt vmcnt(2)
global_load_dwordx4 v[72:75], v9, s[6:7] offset:1024 nt
s_waitcnt vmcnt(2)
global_load_dwordx4 v[76:79], v9, s[6:7] offset:2048 nt
s_waitcnt vmcnt(2)
global_load_dwordx4 v[80:83], v9, s[6:7] offset:3072 nt
s_waitcnt vmcnt(2)
global_load_dwordx4 v[84:87], v15, s[6:7] offset:3072 nt
s_waitcnt vmcnt(2)
global_load_dwordx4 v[88:91], v8, s[8:9] offset:-4096 nt
s_waitcnt vmcnt(2)
global_load_dwordx4 v[92:95], v8, s[8:9] offset:-3072 nt
s_waitcnt vmcnt(2)
global_load_dwordx4 v[96:99], v8, s[8:9] offset:-2048 nt
s_waitcnt vmcnt(2)
global_load_dwordx4 v[100:103], v8, s[8:9] offset:-1024 nt
s_waitcnt vmcnt(2)
global_load_dwordx4 v[104:107], v8, s[8:9] offset:0 nt
v_lshrrev_b32 v14, 3, v2
v_lshlrev_b32 v18, 8, v14
v_lshl_add_u32 v18, v1, 6, v18
v_and_b32 v19, 3, v0
v_lshl_add_u32 v18, v19, 4, v18
v_lshlrev_b32 v14, 5, v14
s_lshl_b32 s46, s3, 2
s_sub_u32 s46, s46, 4
v_add_u32 v19, s46, v14
s_waitcnt lgkmcnt(0)
s_add_u32 s28, s28, 1
v_mov_b32 v29, s28
s_barrier
ds_read_b128 v[20:23], v18 offset:2560
global_load_dwordx4 v[108:111], v8, s[8:9] offset:1024 nt
global_load_dwordx4 v[112:115], v8, s[8:9] offset:2048 nt
global_load_dwordx4 v[116:119], v8, s[8:9] offset:3072 nt
global_load_dwordx4 v[120:123], v17, s[8:9] offset:3072 nt
s_waitcnt lgkmcnt(0)
v_mfma_f32_16x16x32_bf16 v[124:127], v[52:55], v[20:23], 0
v_mfma_f32_16x16x32_bf16 v[128:131], v[56:59], v[20:23], 0
v_mfma_f32_16x16x32_bf16 v[132:135], v[60:63], v[20:23], 0
v_mfma_f32_16x16x32_bf16 v[136:139], v[64:67], v[20:23], 0
v_mfma_f32_16x16x32_bf16 v[140:143], v[68:71], v[20:23], 0
v_mfma_f32_16x16x32_bf16 v[144:147], v[72:75], v[20:23], 0
v_mfma_f32_16x16x32_bf16 v[148:151], v[76:79], v[20:23], 0
v_mfma_f32_16x16x32_bf16 v[152:155], v[80:83], v[20:23], 0
v_mfma_f32_16x16x32_bf16 v[156:159], v[84:87], v[20:23], 0
v_cndmask_b32 v32, v124, v125, s[32:33]
v_cndmask_b32 v33, v128, v129, s[32:33]
v_cndmask_b32 v34, v132, v133, s[32:33]
v_cndmask_b32 v35, v136, v137, s[32:33]
v_cndmask_b32 v36, v140, v141, s[32:33]
v_cndmask_b32 v37, v144, v145, s[32:33]
v_cndmask_b32 v38, v148, v149, s[32:33]
v_cndmask_b32 v39, v152, v153, s[32:33]
v_cndmask_b32 v40, v156, v157, s[32:33]
v_cndmask_b32 v32, v32, v126, s[34:35]
v_cndmask_b32 v33, v33, v130, s[34:35]
v_cndmask_b32 v34, v34, v134, s[34:35]
v_cndmask_b32 v35, v35, v138, s[34:35]
v_cndmask_b32 v36, v36, v142, s[34:35]
v_cndmask_b32 v37, v37, v146, s[34:35]
v_cndmask_b32 v38, v38, v150, s[34:35]
v_cndmask_b32 v39, v39, v154, s[34:35]
v_cndmask_b32 v40, v40, v158, s[34:35]
v_cndmask_b32 v32, v32, v127, s[36:37]
v_cndmask_b32 v33, v33, v131, s[36:37]
v_cndmask_b32 v34, v34, v135, s[36:37]
v_cndmask_b32 v35, v35, v139, s[36:37]
v_cndmask_b32 v36, v36, v143, s[36:37]
v_cndmask_b32 v37, v37, v147, s[36:37]
v_cndmask_b32 v38, v38, v151, s[36:37]
v_cndmask_b32 v39, v39, v155, s[36:37]
v_cndmask_b32 v40, v40, v159, s[36:37]
v_add_f32_dpp v32, v32, v32 quad_perm:[1,0,3,2] row_mask:0xf bank_mask:0xf
v_add_f32_dpp v33, v33, v33 quad_perm:[1,0,3,2] row_mask:0xf bank_mask:0xf
v_add_f32_dpp v34, v34, v34 quad_perm:[1,0,3,2] row_mask:0xf bank_mask:0xf
v_add_f32_dpp v35, v35, v35 quad_perm:[1,0,3,2] row_mask:0xf bank_mask:0xf
v_add_f32_dpp v36, v36, v36 quad_perm:[1,0,3,2] row_mask:0xf bank_mask:0xf
v_add_f32_dpp v37, v37, v37 quad_perm:[1,0,3,2] row_mask:0xf bank_mask:0xf
v_add_f32_dpp v38, v38, v38 quad_perm:[1,0,3,2] row_mask:0xf bank_mask:0xf
v_add_f32_dpp v39, v39, v39 quad_perm:[1,0,3,2] row_mask:0xf bank_mask:0xf
v_add_f32_dpp v40, v40, v40 quad_perm:[1,0,3,2] row_mask:0xf bank_mask:0xf
v_add_f32_dpp v32, v32, v32 quad_perm:[2,3,0,1] row_mask:0xf bank_mask:0xf
v_add_f32_dpp v33, v33, v33 quad_perm:[2,3,0,1] row_mask:0xf bank_mask:0xf
v_add_f32_dpp v34, v34, v34 quad_perm:[2,3,0,1] row_mask:0xf bank_mask:0xf
v_add_f32_dpp v35, v35, v35 quad_perm:[2,3,0,1] row_mask:0xf bank_mask:0xf
v_add_f32_dpp v36, v36, v36 quad_perm:[2,3,0,1] row_mask:0xf bank_mask:0xf
v_add_f32_dpp v37, v37, v37 quad_perm:[2,3,0,1] row_mask:0xf bank_mask:0xf
v_add_f32_dpp v38, v38, v38 quad_perm:[2,3,0,1] row_mask:0xf bank_mask:0xf
v_add_f32_dpp v39, v39, v39 quad_perm:[2,3,0,1] row_mask:0xf bank_mask:0xf
v_add_f32_dpp v40, v40, v40 quad_perm:[2,3,0,1] row_mask:0xf bank_mask:0xf
v_cvt_pk_bf16_f32 v42, v32, v33
v_cvt_pk_bf16_f32 v43, v34, v35
v_cvt_pk_bf16_f32 v44, v36, v37
v_cvt_pk_bf16_f32 v45, v38, v39
v_cvt_pk_bf16_f32 v46, v40, v40
v_lshlrev_b32 v32, 16, v42
v_and_b32 v33, s39, v42
v_lshlrev_b32 v34, 16, v43
v_and_b32 v35, s39, v43
v_lshlrev_b32 v36, 16, v44
v_and_b32 v37, s39, v44
v_lshlrev_b32 v38, 16, v45
v_and_b32 v39, s39, v45
v_lshlrev_b32 v40, 16, v46
v_mul_f32 v32, 0x3db504f3, v32
v_mul_f32 v33, 0x3db504f3, v33
v_mul_f32 v34, 0x3db504f3, v34
v_mul_f32 v35, 0x3db504f3, v35
v_mul_f32 v36, 0x3db504f3, v36
v_mul_f32 v37, 0x3db504f3, v37
v_mul_f32 v38, 0x3db504f3, v38
v_mul_f32 v39, 0x3db504f3, v39
v_mul_f32 v40, 0x3db504f3, v40
v_cvt_pk_bf16_f32 v42, v32, v33
v_cvt_pk_bf16_f32 v43, v34, v35
v_cvt_pk_bf16_f32 v44, v36, v37
v_cvt_pk_bf16_f32 v45, v38, v39
v_cvt_pk_bf16_f32 v46, v40, v40
v_lshlrev_b32 v32, 16, v42
v_and_b32 v33, s39, v42
v_lshlrev_b32 v34, 16, v43
v_and_b32 v35, s39, v43
v_lshlrev_b32 v36, 16, v44
v_and_b32 v37, s39, v44
v_lshlrev_b32 v38, 16, v45
v_and_b32 v39, s39, v45
v_lshlrev_b32 v40, 16, v46
v_max3_f32 v42, v32, v33, v34
v_max3_f32 v42, v42, v35, v36
v_max3_f32 v42, v42, v37, v38
v_max3_f32 v42, v42, v39, v40
v_mov_b32 v43, v42
s_nop 1
v_permlane16_swap_b32 v43, v42
v_max_f32 v42, v42, v43
v_mov_b32 v43, v42
s_nop 1
v_permlane32_swap_b32 v43, v42
v_max_f32 v42, v42, v43
s_mov_b64 exec, 0x101
ds_write_b32 v19, v42 offset:3072
s_mov_b64 exec, -1
s_waitcnt lgkmcnt(0)
s_barrier
ds_read_b128 v[20:23], v14 offset:3072
ds_read_b128 v[24:27], v14 offset:3088
s_waitcnt lgkmcnt(0)
v_max3_f32 v20, v20, v21, v22
v_max3_f32 v23, v23, v24, v25
v_max3_f32 v20, v20, v26, v27
v_max_f32 v20, v20, v23
v_sub_f32 v32, v32, v20
v_sub_f32 v33, v33, v20
v_sub_f32 v34, v34, v20
v_sub_f32 v35, v35, v20
v_sub_f32 v36, v36, v20
v_sub_f32 v37, v37, v20
v_sub_f32 v38, v38, v20
v_sub_f32 v39, v39, v20
v_sub_f32 v40, v40, v20
v_mul_f32 v32, 0x3fb8aa3b, v32
v_mul_f32 v33, 0x3fb8aa3b, v33
v_mul_f32 v34, 0x3fb8aa3b, v34
v_mul_f32 v35, 0x3fb8aa3b, v35
v_mul_f32 v36, 0x3fb8aa3b, v36
v_mul_f32 v37, 0x3fb8aa3b, v37
v_mul_f32 v38, 0x3fb8aa3b, v38
v_mul_f32 v39, 0x3fb8aa3b, v39
v_mul_f32 v40, 0x3fb8aa3b, v40
v_exp_f32 v32, v32
v_exp_f32 v33, v33
v_exp_f32 v34, v34
v_exp_f32 v35, v35
v_exp_f32 v36, v36
v_exp_f32 v37, v37
v_exp_f32 v38, v38
v_exp_f32 v39, v39
v_exp_f32 v40, v40
v_add_f32 v42, v32, v33
v_add_f32 v42, v42, v34
v_add_f32 v42, v42, v35
v_add_f32 v42, v42, v36
v_add_f32 v42, v42, v37
v_add_f32 v42, v42, v38
v_add_f32 v42, v42, v39
v_add_f32 v42, v42, v40
v_cvt_pk_bf16_f32 v32, v32, v32
v_cvt_pk_bf16_f32 v33, v33, v33
v_cvt_pk_bf16_f32 v34, v34, v34
v_cvt_pk_bf16_f32 v35, v35, v35
v_cvt_pk_bf16_f32 v36, v36, v36
v_cvt_pk_bf16_f32 v37, v37, v37
v_cvt_pk_bf16_f32 v38, v38, v38
v_cvt_pk_bf16_f32 v39, v39, v39
v_cvt_pk_bf16_f32 v40, v40, v40
v_mov_b32 v43, v42
s_nop 1
v_permlane16_swap_b32 v43, v42
v_add_f32 v42, v42, v43
v_mov_b32 v43, v42
s_nop 1
v_permlane32_swap_b32 v43, v42
v_add_f32 v42, v42, v43
v_and_b32 v124, v4, v32
v_and_b32 v125, v5, v32
v_and_b32 v126, v6, v32
v_and_b32 v127, v7, v32
v_and_b32 v128, v4, v33
v_and_b32 v129, v5, v33
v_and_b32 v130, v6, v33
v_and_b32 v131, v7, v33
v_and_b32 v132, v4, v34
v_and_b32 v133, v5, v34
v_and_b32 v134, v6, v34
v_and_b32 v135, v7, v34
v_and_b32 v136, v4, v35
v_and_b32 v137, v5, v35
v_and_b32 v138, v6, v35
v_and_b32 v139, v7, v35
v_and_b32 v140, v4, v36
v_and_b32 v141, v5, v36
v_and_b32 v142, v6, v36
v_and_b32 v143, v7, v36
v_and_b32 v144, v4, v37
v_and_b32 v145, v5, v37
v_and_b32 v146, v6, v37
v_and_b32 v147, v7, v37
v_and_b32 v148, v4, v38
v_and_b32 v149, v5, v38
v_and_b32 v150, v6, v38
v_and_b32 v151, v7, v38
v_and_b32 v152, v4, v39
v_and_b32 v153, v5, v39
v_and_b32 v154, v6, v39
v_and_b32 v155, v7, v39
v_and_b32 v156, v4, v40
v_and_b32 v157, v5, v40
v_and_b32 v158, v6, v40
v_and_b32 v159, v7, v40
s_mov_b64 exec, 0x101
ds_write_b32 v19, v42 offset:3136
s_mov_b64 exec, -1
s_lshl_b32 s46, s3, 10
v_add_u32 v18, s46, v8
s_waitcnt vmcnt(8)
v_mfma_f32_16x16x32_bf16 v[20:23], v[124:127], v[88:91], 0
s_waitcnt vmcnt(7)
v_mfma_f32_16x16x32_bf16 v[20:23], v[128:131], v[92:95], v[20:23]
s_waitcnt vmcnt(6)
v_mfma_f32_16x16x32_bf16 v[20:23], v[132:135], v[96:99], v[20:23]
s_waitcnt vmcnt(5)
v_mfma_f32_16x16x32_bf16 v[20:23], v[136:139], v[100:103], v[20:23]
s_waitcnt vmcnt(4)
v_mfma_f32_16x16x32_bf16 v[20:23], v[140:143], v[104:107], v[20:23]
s_waitcnt vmcnt(3)
v_mfma_f32_16x16x32_bf16 v[20:23], v[144:147], v[108:111], v[20:23]
s_waitcnt vmcnt(2)
v_mfma_f32_16x16x32_bf16 v[20:23], v[148:151], v[112:115], v[20:23]
s_waitcnt vmcnt(1)
v_mfma_f32_16x16x32_bf16 v[20:23], v[152:155], v[116:119], v[20:23]
s_waitcnt vmcnt(0)
v_mfma_f32_16x16x32_bf16 v[20:23], v[156:159], v[120:123], v[20:23]
s_nop 7
ds_write_b128 v18, v[20:23] offset:11264
s_waitcnt lgkmcnt(0)
s_barrier
s_barrier
s_cmp_lt_u32 s2, 208
s_cbranch_scc1 L_mlp
s_cmp_lt_u32 s3, 6
s_cbranch_scc0 L_end
s_branch L_red
L_wo:
v_lshrrev_b32 v14, 2, v2
v_lshl_add_u32 v14, v1, 2, v14
v_bfe_u32 v18, v14, 1, 2
v_lshlrev_b32 v18, 1, v18
v_lshlrev_b32 v14, 7, v14
v_add_u32 v14, s47, v14
v_and_b32 v19, 3, v0
v_lshlrev_b32 v19, 1, v19
v_xor_b32 v19, v19, v18
v_lshl_add_u32 v20, v19, 4, v14
v_add_u32 v21, 8, v20
v_add_u32 v22, 16, v20
v_add_u32 v23, 24, v20
s_lshl_b32 s46, s3, 2
v_add_u32 v14, s46, v1
v_mul_u32_u24 v28, 4096, v14
v_lshl_add_u32 v28, v2, 4, v28
s_lshl_b32 s46, s2, 6
s_add_u32 s46, s46, 1048576
s_add_u32 s40, s26, s46
s_addc_u32 s41, s27, 0
v_lshlrev_b32 v24, 4, v1
s_waitcnt vmcnt(2)
ds_read_b64_tr_b16 v[64:65], v20 offset:0
ds_read_b64_tr_b16 v[66:67], v20 offset:2048
ds_read_b64_tr_b16 v[68:69], v20 offset:4096
ds_read_b64_tr_b16 v[70:71], v20 offset:6144
ds_read_b64_tr_b16 v[72:73], v21 offset:0
ds_read_b64_tr_b16 v[74:75], v21 offset:2048
ds_read_b64_tr_b16 v[76:77], v21 offset:4096
ds_read_b64_tr_b16 v[78:79], v21 offset:6144
ds_read_b64_tr_b16 v[80:81], v22 offset:0
ds_read_b64_tr_b16 v[82:83], v22 offset:2048
ds_read_b64_tr_b16 v[84:85], v22 offset:4096
ds_read_b64_tr_b16 v[86:87], v22 offset:6144
ds_read_b64_tr_b16 v[88:89], v23 offset:0
ds_read_b64_tr_b16 v[90:91], v23 offset:2048
ds_read_b64_tr_b16 v[92:93], v23 offset:4096
ds_read_b64_tr_b16 v[94:95], v23 offset:6144
s_cmp_eq_u32 s96, 0
s_cbranch_scc0 L_wo_b5
s_mov_b32 s30, 0
s_and_b32 s97, s28, 0xff
s_mov_b64 s[52:53], s[42:43]
s_add_u32 s42, s52, 3145728
s_addc_u32 s43, s53, 0
s_mov_b64 s[54:55], s[44:45]
s_add_u32 s44, s54, 3145728
s_addc_u32 s45, s55, 0
global_load_dwordx2 v[132:133], v163, s[44:45] sc1
global_load_dwordx4 v[116:119], v8, s[42:43] offset:0 sc1
global_load_dwordx4 v[120:123], v8, s[42:43] offset:1024 sc1
global_load_dwordx4 v[124:127], v8, s[42:43] offset:2048 sc1
global_load_dwordx4 v[128:131], v8, s[42:43] offset:3072 sc1
global_load_dwordx2 v[152:153], v163, s[44:45] sc1
global_load_dwordx4 v[136:139], v8, s[42:43] offset:0 sc1
global_load_dwordx4 v[140:143], v8, s[42:43] offset:1024 sc1
global_load_dwordx4 v[144:147], v8, s[42:43] offset:2048 sc1
global_load_dwordx4 v[148:151], v8, s[42:43] offset:3072 sc1
L_poll_B:
s_waitcnt vmcnt(5)
v_xor_b32 v96, s97, v116
v_xor_b32 v97, s97, v117
v_xor_b32 v98, s97, v118
v_xor_b32 v99, s97, v119
v_xor_b32 v100, s97, v120
v_xor_b32 v101, s97, v121
v_xor_b32 v102, s97, v122
v_xor_b32 v103, s97, v123
v_xor_b32 v104, s97, v124
v_xor_b32 v105, s97, v125
v_xor_b32 v106, s97, v126
v_xor_b32 v107, s97, v127
v_xor_b32 v108, s97, v128
v_xor_b32 v109, s97, v129
v_xor_b32 v110, s97, v130
v_xor_b32 v111, s97, v131
v_xor_b32 v112, s97, v132
v_xor_b32 v113, s97, v133
v_or3_b32 v40, v96, v97, v98
v_or3_b32 v40, v40, v99, v100
v_or3_b32 v40, v40, v101, v102
v_or3_b32 v40, v40, v103, v104
v_or3_b32 v40, v40, v105, v106
v_or3_b32 v40, v40, v107, v108
v_or3_b32 v40, v40, v109, v110
v_or3_b32 v40, v40, v111, v112
v_or3_b32 v40, v40, v113, v113
v_and_b32 v40, 0xff, v40
v_cmp_ne_u32 vcc, 0, v40
s_cbranch_vccz L_got_B
s_add_u32 s30, s30, 1
s_cmp_gt_u32 s30, 30000
s_cbranch_scc1 L_end
s_and_b32 s31, s30, 31
s_cmp_eq_u32 s31, 31
s_cselect_b32 s31, 0, 3145728
s_add_u32 s42, s52, s31
s_addc_u32 s43, s53, 0
s_add_u32 s44, s54, s31
s_addc_u32 s45, s55, 0
s_cmp_eq_u32 s30, 24
s_cbranch_scc0 L_nsp_B
global_store_dwordx4 v161, v[60:63], s[56:57] sc1
s_mov_b32 exec_lo, 1
s_mov_b32 exec_hi, 1
global_store_dwordx2 v162, v[56:57], s[58:59] sc1
s_mov_b64 exec, -1
s_waitcnt vmcnt(0)
L_nsp_B:
global_load_dwordx2 v[132:133], v163, s[44:45] sc1
global_load_dwordx4 v[116:119], v8, s[42:43] offset:0 sc1
global_load_dwordx4 v[120:123], v8, s[42:43] offset:1024 sc1
global_load_dwordx4 v[124:127], v8, s[42:43] offset:2048 sc1
global_load_dwordx4 v[128:131], v8, s[42:43] offset:3072 sc1
s_waitcnt vmcnt(5)
v_xor_b32 v96, s97, v136
v_xor_b32 v97, s97, v137
v_xor_b32 v98, s97, v138
v_xor_b32 v99, s97, v139
v_xor_b32 v100, s97, v140
v_xor_b32 v101, s97, v141
v_xor_b32 v102, s97, v142
v_xor_b32 v103, s97, v143
v_xor_b32 v104, s97, v144
v_xor_b32 v105, s97, v145
v_xor_b32 v106, s97, v146
v_xor_b32 v107, s97, v147
v_xor_b32 v108, s97, v148
v_xor_b32 v109, s97, v149
v_xor_b32 v110, s97, v150
v_xor_b32 v111, s97, v151
v_xor_b32 v112, s97, v152
v_xor_b32 v113, s97, v153
v_or3_b32 v40, v96, v97, v98
v_or3_b32 v40, v40, v99, v100
v_or3_b32 v40, v40, v101, v102
v_or3_b32 v40, v40, v103, v104
v_or3_b32 v40, v40, v105, v106
v_or3_b32 v40, v40, v107, v108
v_or3_b32 v40, v40, v109, v110
v_or3_b32 v40, v40, v111, v112
v_or3_b32 v40, v40, v113, v113
v_and_b32 v40, 0xff, v40
v_cmp_ne_u32 vcc, 0, v40
s_cbranch_vccz L_got_B
global_load_dwordx2 v[152:153], v163, s[44:45] sc1
global_load_dwordx4 v[136:139], v8, s[42:43] offset:0 sc1
global_load_dwordx4 v[140:143], v8, s[42:43] offset:1024 sc1
global_load_dwordx4 v[144:147], v8, s[42:43] offset:2048 sc1
global_load_dwordx4 v[148:151], v8, s[42:43] offset:3072 sc1
s_branch L_poll_B
L_got_B:
v_max_f32_dpp v40, v112, v112 quad_perm:[1,0,3,2] row_mask:0xf bank_mask:0xf
s_nop 1
v_max_f32_dpp v40, v40, v40 quad_perm:[2,3,0,1] row_mask:0xf bank_mask:0xf
v_mov_b32 v41, v40
s_nop 1
v_permlane16_swap_b32 v41, v40
v_max_f32 v40, v40, v41
v_mov_b32 v41, v40
s_nop 1
v_permlane32_swap_b32 v41, v40
v_max_f32 v40, v40, v41
v_sub_f32 v112, v112, v40
v_mul_f32 v112, 0x3fb8aa3b, v112
v_exp_f32 v112, v112
s_nop 0
v_mul_f32 v40, v112, v113
v_mul_f32_dpp v96, v112, v96 quad_perm:[0,0,0,0] row_mask:0xf bank_mask:0xf
v_mul_f32_dpp v97, v112, v97 quad_perm:[0,0,0,0] row_mask:0xf bank_mask:0xf
v_mul_f32_dpp v98, v112, v98 quad_perm:[0,0,0,0] row_mask:0xf bank_mask:0xf
v_mul_f32_dpp v99, v112, v99 quad_perm:[0,0,0,0] row_mask:0xf bank_mask:0xf
v_add_f32_dpp v40, v40, v40 quad_perm:[1,0,3,2] row_mask:0xf bank_mask:0xf
v_fmac_f32_dpp v96, v112, v100 quad_perm:[1,1,1,1] row_mask:0xf bank_mask:0xf
v_fmac_f32_dpp v97, v112, v101 quad_perm:[1,1,1,1] row_mask:0xf bank_mask:0xf
v_fmac_f32_dpp v98, v112, v102 quad_perm:[1,1,1,1] row_mask:0xf bank_mask:0xf
v_fmac_f32_dpp v99, v112, v103 quad_perm:[1,1,1,1] row_mask:0xf bank_mask:0xf
v_add_f32_dpp v40, v40, v40 quad_perm:[2,3,0,1] row_mask:0xf bank_mask:0xf
v_fmac_f32_dpp v96, v112, v104 quad_perm:[2,2,2,2] row_mask:0xf bank_mask:0xf
v_fmac_f32_dpp v97, v112, v105 quad_perm:[2,2,2,2] row_mask:0xf bank_mask:0xf
v_fmac_f32_dpp v98, v112, v106 quad_perm:[2,2,2,2] row_mask:0xf bank_mask:0xf
v_fmac_f32_dpp v99, v112, v107 quad_perm:[2,2,2,2] row_mask:0xf bank_mask:0xf
v_fmac_f32_dpp v96, v112, v108 quad_perm:[3,3,3,3] row_mask:0xf bank_mask:0xf
v_fmac_f32_dpp v97, v112, v109 quad_perm:[3,3,3,3] row_mask:0xf bank_mask:0xf
v_fmac_f32_dpp v98, v112, v110 quad_perm:[3,3,3,3] row_mask:0xf bank_mask:0xf
v_fmac_f32_dpp v99, v112, v111 quad_perm:[3,3,3,3] row_mask:0xf bank_mask:0xf
v_mov_b32 v41, v40
s_nop 1
v_permlane16_swap_b32 v41, v40
v_add_f32 v40, v40, v41
v_mov_b32 v41, v40
s_nop 1
v_permlane32_swap_b32 v41, v40
v_add_f32 v40, v40, v41
v_rcp_f32 v40, v40
v_permlane16_swap_b32 v96, v97
v_permlane16_swap_b32 v98, v99
v_add_f32 v96, v96, v97
v_add_f32 v98, v98, v99
s_nop 1
v_permlane32_swap_b32 v96, v98
v_add_f32 v96, v96, v98
v_mul_f32 v96, v96, v40
v_cvt_pk_bf16_f32 v96, v96, v96
ds_write_b16 v164, v96 offset:3456
L_wo_b5:
s_waitcnt lgkmcnt(0)
s_barrier
ds_read_b128 v[96:99], v24 offset:3456
ds_read_b128 v[100:103], v24 offset:3520
s_waitcnt lgkmcnt(1)
v_mfma_f32_16x16x32_bf16 v[32:35], v[64:67], v[96:99], 0
v_mfma_f32_16x16x32_bf16 v[36:39], v[72:75], v[96:99], 0
v_mfma_f32_16x16x32_bf16 v[40:43], v[80:83], v[96:99], 0
v_mfma_f32_16x16x32_bf16 v[44:47], v[88:91], v[96:99], 0
s_waitcnt lgkmcnt(0)
v_mfma_f32_16x16x32_bf16 v[32:35], v[68:71], v[100:103], v[32:35]
v_mfma_f32_16x16x32_bf16 v[36:39], v[76:79], v[100:103], v[36:39]
v_mfma_f32_16x16x32_bf16 v[40:43], v[84:87], v[100:103], v[40:43]
v_mfma_f32_16x16x32_bf16 v[44:47], v[92:95], v[100:103], v[44:47]
s_nop 5
v_cndmask_b32 v32, v32, v36, s[32:33]
v_cndmask_b32 v33, v33, v37, s[32:33]
v_cndmask_b32 v34, v34, v38, s[32:33]
v_cndmask_b32 v35, v35, v39, s[32:33]
v_cndmask_b32 v32, v32, v40, s[34:35]
v_cndmask_b32 v33, v33, v41, s[34:35]
v_cndmask_b32 v34, v34, v42, s[34:35]
v_cndmask_b32 v35, v35, v43, s[34:35]
v_cndmask_b32 v32, v32, v44, s[36:37]
v_cndmask_b32 v33, v33, v45, s[36:37]
v_cndmask_b32 v34, v34, v46, s[36:37]
v_cndmask_b32 v35, v35, v47, s[36:37]
v_bfi_b32 v32, s38, v32, v29
v_bfi_b32 v33, s38, v33, v29
v_bfi_b32 v34, s38, v34, v29
v_bfi_b32 v35, s38, v35, v29
s_mov_b32 exec_lo, 0x000f000f
s_mov_b32 exec_hi, 0x000f000f
global_store_dwordx4 v28, v[32:35], s[40:41] sc1
s_mov_b64 exec, -1
s_cmp_eq_u32 s96, 0
s_cbranch_scc0 L_end
s_cmp_le_u32 s30, 23
s_cbranch_scc0 L_nsq_B
global_store_dwordx4 v161, v[60:63], s[56:57] sc1
s_mov_b32 exec_lo, 1
s_mov_b32 exec_hi, 1
global_store_dwordx2 v162, v[56:57], s[58:59] sc1
s_mov_b64 exec, -1
L_nsq_B:
s_branch L_end
L_red:
s_sub_u32 s29, s2, 208
s_lshr_b32 s29, s29, 3
s_mul_i32 s29, s29, 6
s_add_u32 s29, s29, s3
s_and_b32 s46, s29, 7
s_and_b32 s48, s2, 7
s_cmp_eq_u32 s46, s48
s_cbranch_scc0 L_end
s_lshl_b32 s49, s29, 5
v_and_b32 v18, 3, v0
v_lshl_add_u32 v16, v18, 2, v1
v_lshl_add_u32 v16, v16, 1, s49
global_load_ushort v17, v16, s[4:5]
v_lshl_add_u32 v16, v18, 3, s49
s_lshl_b32 s46, s29, 12
s_add_u32 s46, s46, 1052672
s_add_u32 s42, s26, s46
s_addc_u32 s43, s27, 0
s_and_b32 s48, s2, 7
s_lshl_b32 s46, s48, 6
s_add_u32 s46, s46, s29
s_lshl_b32 s46, s46, 6
s_add_u32 s46, s46, 1572864
s_add_u32 s44, s26, s46
s_addc_u32 s45, s27, 0
s_add_u32 s52, s44, 3145728
s_addc_u32 s53, s45, 0
v_lshlrev_b32 v14, 4, v18
s_lshl_b32 s46, s29, 6
s_add_u32 s46, s46, 1572864
s_add_u32 s44, s26, s46
s_addc_u32 s45, s27, 0
v_lshrrev_b32 v14, 2, v0
v_lshlrev_b32 v14, 12, v14
v_lshl_add_u32 v14, v18, 4, v14
v_subrev_u32 v20, 1, v29
v_mov_b32 v21, v20
v_mov_b32 v22, v20
v_mov_b32 v23, v20
global_load_ushort v24, v16, s[20:21]
s_waitcnt vmcnt(0)
v_lshlrev_b32 v17, 16, v17
v_add_u32 v19, 1024, v8
s_mov_b32 s30, 0
s_and_b32 s97, s28, 0xff
global_load_dwordx4 v[80:83], v8, s[42:43] offset:-4096 sc1
global_load_dwordx4 v[84:87], v8, s[42:43] offset:-3072 sc1
global_load_dwordx4 v[88:91], v8, s[42:43] offset:-2048 sc1
global_load_dwordx4 v[92:95], v8, s[42:43] offset:-1024 sc1
global_load_dwordx4 v[112:115], v8, s[42:43] offset:-4096 sc1
global_load_dwordx4 v[116:119], v8, s[42:43] offset:-3072 sc1
global_load_dwordx4 v[120:123], v8, s[42:43] offset:-2048 sc1
global_load_dwordx4 v[124:127], v8, s[42:43] offset:-1024 sc1
L_poll_C1:
s_waitcnt vmcnt(4)
v_xor_b32 v96, s97, v80
v_xor_b32 v97, s97, v81
v_xor_b32 v98, s97, v82
v_xor_b32 v99, s97, v83
v_xor_b32 v100, s97, v84
v_xor_b32 v101, s97, v85
v_xor_b32 v102, s97, v86
v_xor_b32 v103, s97, v87
v_xor_b32 v104, s97, v88
v_xor_b32 v105, s97, v89
v_xor_b32 v106, s97, v90
v_xor_b32 v107, s97, v91
v_xor_b32 v108, s97, v92
v_xor_b32 v109, s97, v93
v_xor_b32 v110, s97, v94
v_xor_b32 v111, s97, v95
v_or3_b32 v40, v96, v97, v98
v_or3_b32 v40, v40, v99, v100
v_or3_b32 v40, v40, v101, v102
v_or3_b32 v40, v40, v103, v104
v_or3_b32 v40, v40, v105, v106
v_or3_b32 v40, v40, v107, v108
v_or3_b32 v40, v40, v109, v110
v_or3_b32 v40, v40, v111, v111
v_and_b32 v40, 0xff, v40
v_cmp_ne_u32 vcc, 0, v40
s_cbranch_vccz L_got_C1
s_add_u32 s30, s30, 1
s_cmp_gt_u32 s30, 30000
s_cbranch_scc1 L_end
global_load_dwordx4 v[80:83], v8, s[42:43] offset:-4096 sc1
global_load_dwordx4 v[84:87], v8, s[42:43] offset:-3072 sc1
global_load_dwordx4 v[88:91], v8, s[42:43] offset:-2048 sc1
global_load_dwordx4 v[92:95], v8, s[42:43] offset:-1024 sc1
s_waitcnt vmcnt(4)
v_xor_b32 v96, s97, v112
v_xor_b32 v97, s97, v113
v_xor_b32 v98, s97, v114
v_xor_b32 v99, s97, v115
v_xor_b32 v100, s97, v116
v_xor_b32 v101, s97, v117
v_xor_b32 v102, s97, v118
v_xor_b32 v103, s97, v119
v_xor_b32 v104, s97, v120
v_xor_b32 v105, s97, v121
v_xor_b32 v106, s97, v122
v_xor_b32 v107, s97, v123
v_xor_b32 v108, s97, v124
v_xor_b32 v109, s97, v125
v_xor_b32 v110, s97, v126
v_xor_b32 v111, s97, v127
v_or3_b32 v40, v96, v97, v98
v_or3_b32 v40, v40, v99, v100
v_or3_b32 v40, v40, v101, v102
v_or3_b32 v40, v40, v103, v104
v_or3_b32 v40, v40, v105, v106
v_or3_b32 v40, v40, v107, v108
v_or3_b32 v40, v40, v109, v110
v_or3_b32 v40, v40, v111, v111
v_and_b32 v40, 0xff, v40
v_cmp_ne_u32 vcc, 0, v40
s_cbranch_vccz L_got_C1
global_load_dwordx4 v[112:115], v8, s[42:43] offset:-4096 sc1
global_load_dwordx4 v[116:119], v8, s[42:43] offset:-3072 sc1
global_load_dwordx4 v[120:123], v8, s[42:43] offset:-2048 sc1
global_load_dwordx4 v[124:127], v8, s[42:43] offset:-1024 sc1
s_branch L_poll_C1
L_got_C1:
v_pk_add_f32 v[96:97], v[96:97], v[100:101]
v_pk_add_f32 v[98:99], v[98:99], v[102:103]
v_pk_add_f32 v[104:105], v[104:105], v[108:109]
v_pk_add_f32 v[106:107], v[106:107], v[110:111]
v_pk_add_f32 v[96:97], v[96:97], v[104:105]
v_pk_add_f32 v[98:99], v[98:99], v[106:107]
s_nop 0
v_permlane16_swap_b32 v96, v97
v_permlane16_swap_b32 v98, v99
v_add_f32 v96, v96, v97
v_add_f32 v98, v98, v99
s_nop 1
v_permlane32_swap_b32 v96, v98
v_add_f32 v96, v96, v98
s_nop 1
v_add_f32_dpp v96, v96, v96 row_ror:8 row_mask:0xf bank_mask:0xf
s_nop 1
v_add_f32_dpp v96, v96, v96 row_ror:4 row_mask:0xf bank_mask:0xf
v_cvt_pk_bf16_f32 v96, v96, v96
v_and_b32 v96, s39, v96
v_add_f32 v17, v17, v96
v_cvt_pk_bf16_f32 v17, v17, v17
v_bfi_b32 v20, s39, v17, v29
v_mov_b32 v21, v20
s_nop 1
v_permlane16_swap_b32 v20, v21
v_mov_b32 v22, v20
v_mov_b32 v23, v21
s_nop 0
v_permlane32_swap_b32 v20, v22
v_permlane32_swap_b32 v21, v23
s_mov_b32 exec_hi, 0
global_store_dwordx4 v14, v[20:23], s[44:45] sc1
s_mov_b64 exec, -1
s_and_b32 s46, s29, 7
s_cmp_eq_u32 s46, s48
s_cbranch_scc0 L_end
v_and_b32 v17, s39, v17
s_mul_i32 s46, s29, 9216
s_add_u32 s46, s46, 2101248
s_add_u32 s42, s26, s46
s_addc_u32 s43, s27, 0
s_mov_b32 s30, 0
s_and_b32 s97, s28, 0xff
global_load_dwordx4 v[132:135], v8, s[42:43] offset:-4096 sc1
global_load_dwordx4 v[136:139], v8, s[42:43] offset:-3072 sc1
global_load_dwordx4 v[140:143], v8, s[42:43] offset:-2048 sc1
global_load_dwordx4 v[144:147], v8, s[42:43] offset:-1024 sc1
global_load_dwordx4 v[148:151], v8, s[42:43] offset:0 sc1
global_load_dwordx4 v[152:155], v8, s[42:43] offset:1024 sc1
global_load_dwordx4 v[156:159], v8, s[42:43] offset:2048 sc1
global_load_dwordx4 v[160:163], v8, s[42:43] offset:3072 sc1
global_load_dwordx4 v[164:167], v19, s[42:43] offset:3072 sc1
global_load_dwordx4 v[44:47], v8, s[42:43] offset:-4096 sc1
global_load_dwordx4 v[48:51], v8, s[42:43] offset:-3072 sc1
global_load_dwordx4 v[52:55], v8, s[42:43] offset:-2048 sc1
global_load_dwordx4 v[56:59], v8, s[42:43] offset:-1024 sc1
global_load_dwordx4 v[60:63], v8, s[42:43] offset:0 sc1
global_load_dwordx4 v[64:67], v8, s[42:43] offset:1024 sc1
global_load_dwordx4 v[68:71], v8, s[42:43] offset:2048 sc1
global_load_dwordx4 v[72:75], v8, s[42:43] offset:3072 sc1
global_load_dwordx4 v[76:79], v19, s[42:43] offset:3072 sc1
L_poll_D:
s_waitcnt vmcnt(9)
v_xor_b32 v96, s97, v132
v_xor_b32 v97, s97, v133
v_xor_b32 v98, s97, v134
v_xor_b32 v99, s97, v135
v_xor_b32 v100, s97, v136
v_xor_b32 v101, s97, v137
v_xor_b32 v102, s97, v138
v_xor_b32 v103, s97, v139
v_xor_b32 v104, s97, v140
v_xor_b32 v105, s97, v141
v_xor_b32 v106, s97, v142
v_xor_b32 v107, s97, v143
v_xor_b32 v108, s97, v144
v_xor_b32 v109, s97, v145
v_xor_b32 v110, s97, v146
v_xor_b32 v111, s97, v147
v_xor_b32 v112, s97, v148
v_xor_b32 v113, s97, v149
v_xor_b32 v114, s97, v150
v_xor_b32 v115, s97, v151
v_xor_b32 v116, s97, v152
v_xor_b32 v117, s97, v153
v_xor_b32 v118, s97, v154
v_xor_b32 v119, s97, v155
v_xor_b32 v120, s97, v156
v_xor_b32 v121, s97, v157
v_xor_b32 v122, s97, v158
v_xor_b32 v123, s97, v159
v_xor_b32 v124, s97, v160
v_xor_b32 v125, s97, v161
v_xor_b32 v126, s97, v162
v_xor_b32 v127, s97, v163
v_xor_b32 v128, s97, v164
v_xor_b32 v129, s97, v165
v_xor_b32 v130, s97, v166
v_xor_b32 v131, s97, v167
v_or3_b32 v40, v96, v97, v98
v_or3_b32 v40, v40, v99, v100
v_or3_b32 v40, v40, v101, v102
v_or3_b32 v40, v40, v103, v104
v_or3_b32 v40, v40, v105, v106
v_or3_b32 v40, v40, v107, v108
v_or3_b32 v40, v40, v109, v110
v_or3_b32 v40, v40, v111, v112
v_or3_b32 v40, v40, v113, v114
v_or3_b32 v40, v40, v115, v116
v_or3_b32 v40, v40, v117, v118
v_or3_b32 v40, v40, v119, v120
v_or3_b32 v40, v40, v121, v122
v_or3_b32 v40, v40, v123, v124
v_or3_b32 v40, v40, v125, v126
v_or3_b32 v40, v40, v127, v128
v_or3_b32 v40, v40, v129, v130
v_or3_b32 v40, v40, v131, v131
v_and_b32 v40, 0xff, v40
v_cmp_ne_u32 vcc, 0, v40
s_cbranch_vccz L_got_D
s_add_u32 s30, s30, 1
s_cmp_gt_u32 s30, 30000
s_cbranch_scc1 L_end
global_load_dwordx4 v[132:135], v8, s[42:43] offset:-4096 sc1
global_load_dwordx4 v[136:139], v8, s[42:43] offset:-3072 sc1
global_load_dwordx4 v[140:143], v8, s[42:43] offset:-2048 sc1
global_load_dwordx4 v[144:147], v8, s[42:43] offset:-1024 sc1
global_load_dwordx4 v[148:151], v8, s[42:43] offset:0 sc1
global_load_dwordx4 v[152:155], v8, s[42:43] offset:1024 sc1
global_load_dwordx4 v[156:159], v8, s[42:43] offset:2048 sc1
global_load_dwordx4 v[160:163], v8, s[42:43] offset:3072 sc1
global_load_dwordx4 v[164:167], v19, s[42:43] offset:3072 sc1
s_waitcnt vmcnt(9)
v_xor_b32 v96, s97, v44
v_xor_b32 v97, s97, v45
v_xor_b32 v98, s97, v46
v_xor_b32 v99, s97, v47
v_xor_b32 v100, s97, v48
v_xor_b32 v101, s97, v49
v_xor_b32 v102, s97, v50
v_xor_b32 v103, s97, v51
v_xor_b32 v104, s97, v52
v_xor_b32 v105, s97, v53
v_xor_b32 v106, s97, v54
v_xor_b32 v107, s97, v55
v_xor_b32 v108, s97, v56
v_xor_b32 v109, s97, v57
v_xor_b32 v110, s97, v58
v_xor_b32 v111, s97, v59
v_xor_b32 v112, s97, v60
v_xor_b32 v113, s97, v61
v_xor_b32 v114, s97, v62
v_xor_b32 v115, s97, v63
v_xor_b32 v116, s97, v64
v_xor_b32 v117, s97, v65
v_xor_b32 v118, s97, v66
v_xor_b32 v119, s97, v67
v_xor_b32 v120, s97, v68
v_xor_b32 v121, s97, v69
v_xor_b32 v122, s97, v70
v_xor_b32 v123, s97, v71
v_xor_b32 v124, s97, v72
v_xor_b32 v125, s97, v73
v_xor_b32 v126, s97, v74
v_xor_b32 v127, s97, v75
v_xor_b32 v128, s97, v76
v_xor_b32 v129, s97, v77
v_xor_b32 v130, s97, v78
v_xor_b32 v131, s97, v79
v_or3_b32 v40, v96, v97, v98
v_or3_b32 v40, v40, v99, v100
v_or3_b32 v40, v40, v101, v102
v_or3_b32 v40, v40, v103, v104
v_or3_b32 v40, v40, v105, v106
v_or3_b32 v40, v40, v107, v108
v_or3_b32 v40, v40, v109, v110
v_or3_b32 v40, v40, v111, v112
v_or3_b32 v40, v40, v113, v114
v_or3_b32 v40, v40, v115, v116
v_or3_b32 v40, v40, v117, v118
v_or3_b32 v40, v40, v119, v120
v_or3_b32 v40, v40, v121, v122
v_or3_b32 v40, v40, v123, v124
v_or3_b32 v40, v40, v125, v126
v_or3_b32 v40, v40, v127, v128
v_or3_b32 v40, v40, v129, v130
v_or3_b32 v40, v40, v131, v131
v_and_b32 v40, 0xff, v40
v_cmp_ne_u32 vcc, 0, v40
s_cbranch_vccz L_got_D
global_load_dwordx4 v[44:47], v8, s[42:43] offset:-4096 sc1
global_load_dwordx4 v[48:51], v8, s[42:43] offset:-3072 sc1
global_load_dwordx4 v[52:55], v8, s[42:43] offset:-2048 sc1
global_load_dwordx4 v[56:59], v8, s[42:43] offset:-1024 sc1
global_load_dwordx4 v[60:63], v8, s[42:43] offset:0 sc1
global_load_dwordx4 v[64:67], v8, s[42:43] offset:1024 sc1
global_load_dwordx4 v[68:71], v8, s[42:43] offset:2048 sc1
global_load_dwordx4 v[72:75], v8, s[42:43] offset:3072 sc1
global_load_dwordx4 v[76:79], v19, s[42:43] offset:3072 sc1
s_branch L_poll_D
L_got_D:
v_pk_add_f32 v[96:97], v[96:97], v[100:101]
v_pk_add_f32 v[98:99], v[98:99], v[102:103]
v_pk_add_f32 v[104:105], v[104:105], v[108:109]
v_pk_add_f32 v[106:107], v[106:107], v[110:111]
v_pk_add_f32 v[112:113], v[112:113], v[116:117]
v_pk_add_f32 v[114:115], v[114:115], v[118:119]
v_pk_add_f32 v[120:121], v[120:121], v[124:125]
v_pk_add_f32 v[122:123], v[122:123], v[126:127]
v_pk_add_f32 v[96:97], v[96:97], v[128:129]
v_pk_add_f32 v[98:99], v[98:99], v[130:131]
v_pk_add_f32 v[104:105], v[104:105], v[112:113]
v_pk_add_f32 v[106:107], v[106:107], v[114:115]
v_pk_add_f32 v[96:97], v[96:97], v[120:121]
v_pk_add_f32 v[98:99], v[98:99], v[122:123]
v_pk_add_f32 v[96:97], v[96:97], v[104:105]
v_pk_add_f32 v[98:99], v[98:99], v[106:107]
s_nop 0
v_permlane16_swap_b32 v96, v97
v_permlane16_swap_b32 v98, v99
v_add_f32 v96, v96, v97
v_add_f32 v98, v98, v99
s_nop 1
v_permlane32_swap_b32 v96, v98
v_add_f32 v96, v96, v98
s_nop 1
v_add_f32_dpp v96, v96, v96 row_ror:8 row_mask:0xf bank_mask:0xf
s_nop 1
v_add_f32_dpp v96, v96, v96 row_ror:4 row_mask:0xf bank_mask:0xf
v_cvt_pk_bf16_f32 v96, v96, v96
v_and_b32 v96, s39, v96
v_add_f32 v17, v17, v96
v_mov_b32 v20, v17
v_mov_b32 v21, v20
s_nop 1
v_permlane16_swap_b32 v20, v21
v_mov_b32 v22, v20
v_mov_b32 v23, v21
s_nop 0
v_permlane32_swap_b32 v20, v22
v_permlane32_swap_b32 v21, v23
v_cvt_pk_bf16_f32 v20, v20, v21
v_cvt_pk_bf16_f32 v21, v22, v23
s_mov_b64 exec, 15
global_store_dwordx2 v16, v[20:21], s[20:21]
s_cmp_eq_u32 s29, 0
s_cbranch_scc0 L_end
s_mov_b64 exec, 1
v_mov_b32 v14, 0
global_store_dword v14, v29, s[26:27] sc1
s_branch L_end
L_mlp:
s_cmp_le_u32 s3, 0
s_cbranch_scc1 L_mlp_w2
s_add_u32 s49, s47, 0
s_mov_b32 m0, s49
s_nop 0
global_load_lds_dwordx4 v11, s[16:17] nt
s_add_u32 s16, s16, 147456
s_addc_u32 s17, s17, 0
s_add_u32 s49, s47, 1024
s_mov_b32 m0, s49
s_nop 0
global_load_lds_dwordx4 v11, s[16:17] nt
s_add_u32 s16, s16, 147456
s_addc_u32 s17, s17, 0
s_add_u32 s49, s47, 2048
s_mov_b32 m0, s49
s_nop 0
global_load_lds_dwordx4 v11, s[16:17] nt
s_add_u32 s16, s16, 147456
s_addc_u32 s17, s17, 0
s_add_u32 s49, s47, 3072
s_mov_b32 m0, s49
s_nop 0
global_load_lds_dwordx4 v11, s[16:17] nt
s_add_u32 s16, s16, 147456
s_addc_u32 s17, s17, 0
L_mlp_w2:
s_cmp_eq_u32 s96, 0
s_cbranch_scc1 L_mlp_wd
s_add_u32 s49, s47, 4096
s_mov_b32 m0, s49
s_nop 0
global_load_lds_dwordx4 v10, s[18:19] nt
s_add_u32 s18, s18, 9216
s_addc_u32 s19, s19, 0
s_add_u32 s49, s47, 5120
s_mov_b32 m0, s49
s_nop 0
global_load_lds_dwordx4 v10, s[18:19] nt
s_add_u32 s18, s18, 9216
s_addc_u32 s19, s19, 0
s_add_u32 s49, s47, 6144
s_mov_b32 m0, s49
s_nop 0
global_load_lds_dwordx4 v10, s[18:19] nt
s_add_u32 s18, s18, 9216
s_addc_u32 s19, s19, 0
s_add_u32 s49, s47, 7168
s_mov_b32 m0, s49
s_nop 0
global_load_lds_dwordx4 v10, s[18:19] nt
s_add_u32 s18, s18, 9216
s_addc_u32 s19, s19, 0
L_mlp_wd:
s_add_u32 s48, s47, 4096
v_lshrrev_b32 v14, 2, v2
v_lshl_add_u32 v14, v1, 2, v14
v_bfe_u32 v18, v14, 1, 2
v_lshlrev_b32 v18, 1, v18
v_lshlrev_b32 v14, 7, v14
v_add_u32 v14, s48, v14
v_and_b32 v19, 3, v0
v_lshlrev_b32 v19, 1, v19
v_xor_b32 v19, v19, v18
v_lshl_add_u32 v20, v19, 4, v14
v_add_u32 v21, 8, v20
v_add_u32 v22, 16, v20
v_add_u32 v23, 24, v20
s_lshl_b32 s46, s3, 2
v_add_u32 v14, s46, v1
v_mul_u32_u24 v28, 9216, v14
v_lshl_add_u32 v28, v2, 4, v28
s_lshl_b32 s46, s29, 6
s_add_u32 s46, s46, 2097152
s_add_u32 s40, s26, s46
s_addc_u32 s41, s27, 0
v_lshrrev_b32 v14, 2, v2
v_lshl_add_u32 v14, v1, 2, v14
v_lshlrev_b32 v30, 6, v14
v_and_b32 v14, 3, v0
v_lshl_add_u32 v30, v14, 3, v30
v_add_u32 v30, s47, v30
s_lshl_b32 s46, s3, 7
v_lshlrev_b32 v31, 4, v1
v_add_u32 v31, s46, v31
v_bfe_u32 v33, v0, 2, 1
v_lshlrev_b32 v33, 2, v33
v_add_u32 v33, v33, v1
v_lshl_add_u32 v33, v33, 2, v14
v_lshlrev_b32 v33, 2, v33
s_waitcnt vmcnt(4)
ds_read_b64_tr_b16 v[64:65], v30 offset:0
ds_read_b64_tr_b16 v[66:67], v30 offset:1024
ds_read_b64_tr_b16 v[68:69], v30 offset:32
ds_read_b64_tr_b16 v[70:71], v30 offset:1056
ds_read_b64_tr_b16 v[72:73], v30 offset:2048
ds_read_b64_tr_b16 v[74:75], v30 offset:3072
ds_read_b64_tr_b16 v[76:77], v30 offset:2080
ds_read_b64_tr_b16 v[78:79], v30 offset:3104
s_waitcnt vmcnt(0)
ds_read_b64_tr_b16 v[96:97], v20 offset:0
ds_read_b64_tr_b16 v[98:99], v20 offset:2048
ds_read_b64_tr_b16 v[100:101], v21 offset:0
ds_read_b64_tr_b16 v[102:103], v21 offset:2048
ds_read_b64_tr_b16 v[104:105], v22 offset:0
ds_read_b64_tr_b16 v[106:107], v22 offset:2048
ds_read_b64_tr_b16 v[108:109], v23 offset:0
ds_read_b64_tr_b16 v[110:111], v23 offset:2048
s_cmp_eq_u32 s96, 0
s_cbranch_scc0 L_mlp_b5
s_and_b32 s46, s2, 7
s_lshl_b32 s46, s46, 12
s_add_u32 s46, s46, 1572864
s_add_u32 s42, s26, s46
s_addc_u32 s43, s27, 0
v_lshlrev_b32 v9, 2, v0
v_lshrrev_b32 v19, 3, v0
v_lshlrev_b32 v18, 6, v19
v_lshl_add_u32 v18, v14, 4, v18
v_bfe_u32 v19, v0, 2, 1
v_lshl_add_u32 v18, v19, 3, v18
v_bfe_u32 v34, v0, 2, 2
v_lshlrev_b32 v19, 4, v34
v_bfe_u32 v34, v0, 4, 1
v_lshl_add_u32 v19, v34, 3, v19
v_lshl_add_u32 v19, v14, 1, v19
v_lshrrev_b32 v34, 5, v0
v_lshl_add_u32 v19, v34, 6, v19
s_mov_b32 s30, 0
s_and_b32 s97, s28, 0xffff
global_load_dwordx4 v[112:115], v8, s[42:43] sc1
global_load_dwordx4 v[116:119], v8, s[42:43] offset:1024 sc1
global_load_dword v120, v9, s[42:43] offset:2048 sc1
global_load_dwordx4 v[80:83], v8, s[42:43] sc1
global_load_dwordx4 v[84:87], v8, s[42:43] offset:1024 sc1
global_load_dword v88, v9, s[42:43] offset:2048 sc1
L_poll_C2:
s_waitcnt vmcnt(3)
v_xor_b32 v128, s97, v112
v_xor_b32 v129, s97, v113
v_xor_b32 v130, s97, v114
v_xor_b32 v131, s97, v115
v_xor_b32 v132, s97, v116
v_xor_b32 v133, s97, v117
v_xor_b32 v134, s97, v118
v_xor_b32 v135, s97, v119
v_xor_b32 v136, s97, v120
v_or3_b32 v40, v128, v129, v130
v_or3_b32 v40, v40, v131, v132
v_or3_b32 v40, v40, v133, v134
v_or3_b32 v40, v40, v135, v136
v_cmp_ne_u16 vcc, 0, v40
s_cbranch_vccz L_got_C2
s_add_u32 s30, s30, 1
s_cmp_gt_u32 s30, 30000
s_cbranch_scc1 L_end
global_load_dwordx4 v[112:115], v8, s[42:43] sc1
global_load_dwordx4 v[116:119], v8, s[42:43] offset:1024 sc1
global_load_dword v120, v9, s[42:43] offset:2048 sc1
s_waitcnt vmcnt(3)
v_xor_b32 v128, s97, v80
v_xor_b32 v129, s97, v81
v_xor_b32 v130, s97, v82
v_xor_b32 v131, s97, v83
v_xor_b32 v132, s97, v84
v_xor_b32 v133, s97, v85
v_xor_b32 v134, s97, v86
v_xor_b32 v135, s97, v87
v_xor_b32 v136, s97, v88
v_or3_b32 v40, v128, v129, v130
v_or3_b32 v40, v40, v131, v132
v_or3_b32 v40, v40, v133, v134
v_or3_b32 v40, v40, v135, v136
v_cmp_ne_u16 vcc, 0, v40
s_cbranch_vccz L_got_C2
global_load_dwordx4 v[80:83], v8, s[42:43] sc1
global_load_dwordx4 v[84:87], v8, s[42:43] offset:1024 sc1
global_load_dword v88, v9, s[42:43] offset:2048 sc1
s_branch L_poll_C2
L_got_C2:
v_add_f32 v140, v128, v129
v_mul_f32 v142, v128, v128
v_add_f32 v140, v140, v130
v_fmac_f32 v142, v129, v129
v_add_f32 v140, v140, v131
v_fmac_f32 v142, v130, v130
v_add_f32 v140, v140, v132
v_fmac_f32 v142, v131, v131
v_add_f32 v140, v140, v133
v_fmac_f32 v142, v132, v132
v_add_f32 v140, v140, v134
v_fmac_f32 v142, v133, v133
v_add_f32 v140, v140, v135
v_fmac_f32 v142, v134, v134
v_add_f32 v140, v140, v136
v_fmac_f32 v142, v135, v135
v_fmac_f32 v142, v136, v136
v_add_f32_dpp v140, v140, v140 row_ror:8 row_mask:0xf bank_mask:0xf
s_nop 0
v_add_f32_dpp v142, v142, v142 row_ror:8 row_mask:0xf bank_mask:0xf
v_add_f32_dpp v140, v140, v140 row_ror:4 row_mask:0xf bank_mask:0xf
s_nop 0
v_add_f32_dpp v142, v142, v142 row_ror:4 row_mask:0xf bank_mask:0xf
v_add_f32_dpp v140, v140, v140 row_ror:2 row_mask:0xf bank_mask:0xf
s_nop 0
v_add_f32_dpp v142, v142, v142 row_ror:2 row_mask:0xf bank_mask:0xf
v_add_f32_dpp v140, v140, v140 row_ror:1 row_mask:0xf bank_mask:0xf
s_nop 0
v_add_f32_dpp v142, v142, v142 row_ror:1 row_mask:0xf bank_mask:0xf
v_add_f32_dpp v140, v140, v140 row_bcast:15 row_mask:0xa bank_mask:0xf
s_nop 0
v_add_f32_dpp v142, v142, v142 row_bcast:15 row_mask:0xa bank_mask:0xf
v_add_f32_dpp v140, v140, v140 row_bcast:31 row_mask:0xc bank_mask:0xf
s_nop 0
v_add_f32_dpp v142, v142, v142 row_bcast:31 row_mask:0xc bank_mask:0xf
v_readlane_b32 s46, v140, 63
v_readlane_b32 s31, v142, 63
v_mov_b32 v140, 0x3ae38e39
v_mul_f32 v141, s46, v140
v_mul_f32 v140, s31, v140
v_fma_f32 v140, -v141, v141, v140
v_max_f32 v140, 0, v140
v_cvt_pk_bf16_f32 v141, v141, v141
v_and_b32 v141, s39, v141
v_sub_f32 v128, v128, v141
v_sub_f32 v129, v129, v141
v_sub_f32 v130, v130, v141
v_sub_f32 v131, v131, v141
v_sub_f32 v132, v132, v141
v_sub_f32 v133, v133, v141
v_sub_f32 v134, v134, v141
v_sub_f32 v135, v135, v141
v_sub_f32 v136, v136, v141
v_cvt_pk_bf16_f32 v140, v140, v140
v_and_b32 v140, s39, v140
v_add_f32 v140, 0x3727c5ac, v140
v_cvt_pk_bf16_f32 v140, v140, v140
v_and_b32 v140, s39, v140
v_sqrt_f32 v140, v140
v_cvt_pk_bf16_f32 v142, v128, v129
v_lshlrev_b32 v128, 16, v142
v_and_b32 v129, s39, v142
v_cvt_pk_bf16_f32 v142, v130, v131
v_lshlrev_b32 v130, 16, v142
v_and_b32 v131, s39, v142
v_cvt_pk_bf16_f32 v142, v132, v133
v_lshlrev_b32 v132, 16, v142
v_and_b32 v133, s39, v142
v_cvt_pk_bf16_f32 v142, v134, v135
v_lshlrev_b32 v134, 16, v142
v_and_b32 v135, s39, v142
v_cvt_pk_bf16_f32 v136, v136, v136
v_and_b32 v136, s39, v136
v_cvt_pk_bf16_f32 v140, v140, v140
v_and_b32 v140, s39, v140
v_rcp_f32 v141, v140
s_nop 0
v_mul_f32 v128, v128, v141
v_mul_f32 v129, v129, v141
v_mul_f32 v130, v130, v141
v_mul_f32 v131, v131, v141
v_mul_f32 v132, v132, v141
v_mul_f32 v133, v133, v141
v_mul_f32 v134, v134, v141
v_mul_f32 v135, v135, v141
v_mul_f32 v136, v136, v141
v_cvt_pk_bf16_f32 v140, v128, v129
v_cvt_pk_bf16_f32 v141, v130, v131
v_cvt_pk_bf16_f32 v142, v132, v133
v_cvt_pk_bf16_f32 v143, v134, v135
v_cvt_pk_bf16_f32 v144, v136, v136
ds_write_b64 v18, v[140:141] offset:4096
ds_write_b64 v18, v[142:143] offset:4608
ds_write_b16 v19, v144 offset:5120
L_mlp_b5:
s_waitcnt lgkmcnt(0)
s_barrier
ds_read_b128 v[36:39], v31 offset:4096
ds_read_b128 v[40:43], v31 offset:4160
s_waitcnt lgkmcnt(1)
v_mfma_f32_16x16x32_bf16 v[44:47], v[64:67], v[36:39], 0
v_mfma_f32_16x16x32_bf16 v[48:51], v[68:71], v[36:39], 0
s_waitcnt lgkmcnt(0)
v_mfma_f32_16x16x32_bf16 v[44:47], v[72:75], v[40:43], v[44:47]
v_mfma_f32_16x16x32_bf16 v[48:51], v[76:79], v[40:43], v[48:51]
s_mov_b32 exec_lo, 0x00010001
s_mov_b32 exec_hi, 0x00010001
s_nop 4
ds_write_b128 v31, v[44:47] offset:6144
ds_write_b128 v31, v[48:51] offset:6208
s_mov_b64 exec, -1
s_waitcnt lgkmcnt(0)
s_barrier
ds_read_b32 v44, v33 offset:6144
ds_read_b32 v45, v33 offset:6272
ds_read_b32 v46, v33 offset:6400
ds_read_b32 v47, v33 offset:6528
ds_read_b32 v48, v33 offset:6656
ds_read_b32 v49, v33 offset:6784
ds_read_b32 v50, v33 offset:6912
ds_read_b32 v51, v33 offset:7040
ds_read_b32 v52, v33 offset:7168
s_waitcnt lgkmcnt(0)
v_add_f32 v44, v44, v45
v_add_f32 v46, v46, v47
v_add_f32 v48, v48, v49
v_add_f32 v50, v50, v51
v_add_f32 v44, v44, v46
v_add_f32 v48, v48, v50
v_add_f32 v44, v44, v52
v_add_f32 v44, v44, v48
v_max_f32 v44, 0, v44
s_nop 1
v_mov_b32_dpp v45, v44 quad_perm:[1,0,3,2] row_mask:0xf bank_mask:0xf
v_cvt_pk_bf16_f32 v44, v44, v45
s_nop 1
v_mov_b32_dpp v36, v44 row_newbcast:0 row_mask:0xf bank_mask:0xf
v_mov_b32_dpp v37, v44 row_newbcast:2 row_mask:0xf bank_mask:0xf
v_mov_b32_dpp v38, v44 row_newbcast:4 row_mask:0xf bank_mask:0xf
v_mov_b32_dpp v39, v44 row_newbcast:6 row_mask:0xf bank_mask:0xf
s_nop 1
v_mfma_f32_16x16x32_bf16 v[44:47], v[96:99], v[36:39], 0
v_mfma_f32_16x16x32_bf16 v[48:51], v[100:103], v[36:39], 0
v_mfma_f32_16x16x32_bf16 v[52:55], v[104:107], v[36:39], 0
v_mfma_f32_16x16x32_bf16 v[56:59], v[108:111], v[36:39], 0
s_nop 5
v_cndmask_b32 v44, v44, v48, s[32:33]
v_cndmask_b32 v45, v45, v49, s[32:33]
v_cndmask_b32 v46, v46, v50, s[32:33]
v_cndmask_b32 v47, v47, v51, s[32:33]
v_cndmask_b32 v44, v44, v52, s[34:35]
v_cndmask_b32 v45, v45, v53, s[34:35]
v_cndmask_b32 v46, v46, v54, s[34:35]
v_cndmask_b32 v47, v47, v55, s[34:35]
v_cndmask_b32 v44, v44, v56, s[36:37]
v_cndmask_b32 v45, v45, v57, s[36:37]
v_cndmask_b32 v46, v46, v58, s[36:37]
v_cndmask_b32 v47, v47, v59, s[36:37]
v_bfi_b32 v44, s38, v44, v29
v_bfi_b32 v45, s38, v45, v29
v_bfi_b32 v46, s38, v46, v29
v_bfi_b32 v47, s38, v47, v29
s_mov_b32 exec_lo, 0x000f000f
s_mov_b32 exec_hi, 0x000f000f
global_store_dwordx4 v28, v[44:47], s[40:41] sc1
s_mov_b64 exec, -1
L_end:
L_exit:
s_endpgm
.section .rodata,"a"
.p2align 6
.amdhsa_kernel sequential_preLN__sliding_block_cached__dense_activation_relu__decode_kernel
  .amdhsa_next_free_vgpr 168
  .amdhsa_next_free_sgpr 102
  .amdhsa_accum_offset 168
  .amdhsa_group_segment_fixed_size 0
  .amdhsa_kernarg_size 88
  .amdhsa_user_sgpr_count 2
  .amdhsa_user_sgpr_kernarg_segment_ptr 1
  .amdhsa_system_sgpr_workgroup_id_x 1
.end_amdhsa_kernel
```
